```python
import torch

def _softmax(x, axis=-1):
    return torch.softmax(x, dim=axis)

def _gelu(x):
    return torch.nn.functional.gelu(x, approximate='tanh')

def _silu(x):
    return torch.nn.functional.silu(x)

def _sigmoid(x):
    return torch.sigmoid(x)

def _layernorm(x, axis=-1, eps=1e-05):
    m = x.mean(dim=axis, keepdim=True)
    v = x.var(dim=axis, keepdim=True, unbiased=False)
    return (x - m) / torch.sqrt(v + eps)

def _scatter_add(tgt, idx, src, axis=0):
    return tgt.clone().index_add_(axis, idx, src)

def _segment_sum(src, seg, n):
    out = torch.zeros((n,) + src.shape[1:], dtype=src.dtype)
    return out.index_add_(0, seg, src)

def _pad(x, pw):
    flat = tuple((v for pair in reversed(pw) for v in pair))
    return torch.nn.functional.pad(x, flat)
kernel_name = 'adaLN_cond__linear_kernel_hedgehog__glu_gated_bilinear__prompt'

def setup_inputs():

    _w = lambda a: (lambda t: t.to(torch.bfloat16) if t.is_floating_point() else t)(torch.as_tensor(a))

    def _A_setup():
        B, S, D, H = (1, 2048, 512, 32)
        Dh = D // H
        return {'x': _w((lambda *s: torch.randn(*s, dtype=torch.bfloat16) * 0.1)(B, S, D)), 'wqkv': _w((lambda *s: torch.randn(*s, dtype=torch.bfloat16) * 0.2)(D, 3 * D)), 'w_phi': _w((lambda *s: torch.randn(*s, dtype=torch.bfloat16) * 0.2)(H, Dh, Dh) * Dh ** (-0.5)), 'wo': _w((lambda *s: torch.randn(*s, dtype=torch.bfloat16) * 0.2)(D, D))}
    _A_in = _A_setup()

    def _B_setup():
        B, S, D, F = (1, 2048, 512, 1376)
        return {'x': _w((lambda *s: torch.randn(*s, dtype=torch.bfloat16) * 0.1)(B, S, D)), 'w_gate': _w((lambda *s: torch.randn(*s, dtype=torch.bfloat16) * 3.2)(D, F) * D ** (-0.5)), 'w_up': _w((lambda *s: torch.randn(*s, dtype=torch.bfloat16) * 3.2)(D, F) * D ** (-0.5)), 'w_down': _w((lambda *s: torch.randn(*s, dtype=torch.bfloat16) * 3.2)(F, D) * F ** (-0.5))}
    _B_in = _B_setup()
    return {'A_x': _A_in['x'], 'A_wqkv': _A_in['wqkv'], 'A_w_phi': _A_in['w_phi'], 'A_wo': _A_in['wo'], 'B_x': _B_in['x'], 'B_w_gate': _B_in['w_gate'], 'B_w_up': _B_in['w_up'], 'B_w_down': _B_in['w_down'], 'c': _w((lambda *s: torch.randn(*s, dtype=torch.bfloat16) * 0.4)(1, 512) * 8.0), 'w_mod': _w((lambda *s: torch.randn(*s, dtype=torch.bfloat16) * 0.4)(512, 6 * 512) * 512 ** (-0.5) * 8.0)}

def reference(A_x, A_wqkv, A_w_phi, A_wo, B_x, B_w_gate, B_w_up, B_w_down, c, w_mod):

    def _A_ref(x, wqkv, w_phi, wo):
        B, S, D = x.shape
        H = 32
        Dh = D // H
        qkv = (lambda x, *d: x.permute(*d))((x @ wqkv).reshape(B, S, 3, H, Dh), 2, 0, 3, 1, 4)
        q, k, v = (qkv[0], qkv[1], qkv[2])
        pq = torch.einsum('bhsd,hdf->bhsf', q, w_phi)
        pk = torch.einsum('bhsd,hdf->bhsf', k, w_phi)
        phi_q = torch.concatenate([_softmax(pq, axis=-1), _softmax(-pq, axis=-1)], axis=-1)
        phi_k = torch.concatenate([_softmax(pk, axis=-1), _softmax(-pk, axis=-1)], axis=-1)
        kv = torch.einsum('bhsf,bhsd->bhfd', phi_k, v)
        z = torch.einsum('bhsf->bhf', phi_k)
        num = torch.einsum('bhqf,bhfd->bhqd', phi_q, kv)
        den = torch.einsum('bhqf,bhf->bhq', phi_q, z)[..., None] + 1e-06
        o = num / den
        return (lambda x, *d: x.permute(*d))(o, 0, 2, 1, 3).reshape(B, S, D) @ wo

    def _B_ref(x, w_gate, w_up, w_down):
        g = torch.einsum('bsd,df->bsf', x, w_gate)
        u = torch.einsum('bsd,df->bsf', x, w_up)
        h = g * u
        return torch.einsum('bsf,fd->bsd', h, w_down)
    x = A_x
    mod = (_silu(c) @ w_mod).reshape(c.shape[0], 6, 1, -1)
    sa, ca, ga, sb, cb, gb = (mod[:, 0].clone(), mod[:, 1].clone(), mod[:, 2].clone(), mod[:, 3].clone(), mod[:, 4].clone(), mod[:, 5].clone())
    h = _layernorm(x, axis=-1) * (1 + ca) + sa
    x = x + ga * _A_ref(h, A_wqkv, A_w_phi, A_wo)
    h = _layernorm(x, axis=-1) * (1 + cb) + sb
    x = x + gb * _B_ref(h, B_w_gate, B_w_up, B_w_down)
    return x
```

```asm
; @launch grid=(256,1,1) block=(256,1,1) lds=163840
.amdgcn_target "amdgcn-amd-amdhsa--gfx950"
.text
.globl adaLN_cond__linear_kernel_hedgehog__glu_gated_bilinear__prompt_kernel
.p2align 8
.type adaLN_cond__linear_kernel_hedgehog__glu_gated_bilinear__prompt_kernel,@function
adaLN_cond__linear_kernel_hedgehog__glu_gated_bilinear__prompt_kernel:
    s_cmp_ge_u32 s2, 256
    s_cbranch_scc1 L_end
    s_load_dwordx2 s[72:73], s[0:1], 64
    s_load_dwordx2 s[76:77], s[0:1], 72
    s_load_dwordx2 s[44:45], s[0:1], 0
    s_load_dwordx2 s[84:85], s[0:1], 96
    s_load_dwordx2 s[48:49], s[0:1], 8
    s_load_dwordx2 s[52:53], s[0:1], 16
    s_load_dwordx2 s[56:57], s[0:1], 24
    s_load_dwordx2 s[60:61], s[0:1], 40
    s_load_dwordx2 s[64:65], s[0:1], 48
    s_load_dwordx2 s[68:69], s[0:1], 56
    s_load_dwordx2 s[80:81], s[0:1], 80
    s_getpc_b64 s[100:101]
L_pc:
    s_lshr_b32 s6, s2, 3
    s_and_b32 s11, s6, 15
    s_lshl_b32 s11, s11, 12
    v_lshlrev_b32 v6, 4, v0
    v_add_u32 v6, s11, v6
    v_min_u32 v6, L_code_end-L_pc-16, v6
    global_load_dwordx4 v[60:63], v6, s[100:101]
    v_and_b32 v1, 63, v0
    v_lshrrev_b32 v6, 6, v0
    v_lshrrev_b32 v2, 4, v1
    v_and_b32 v3, 15, v0
    v_readfirstlane_b32 s5, v6
    v_lshlrev_b32 v5, 4, v1
    s_and_b32 s3, s2, 7
    s_mov_b32 s74, 1024
    s_mov_b32 s75, 0x20000
    s_mov_b32 s78, 3145728
    s_mov_b32 s79, 0x20000
    s_mov_b32 s46, 2097152
    s_mov_b32 s47, 0x20000
    s_mov_b32 s86, 33554432
    s_mov_b32 s87, 0x20000
    s_mov_b32 s50, 1572864
    s_mov_b32 s51, 0x20000
    s_mov_b32 s54, 16384
    s_mov_b32 s55, 0x20000
    s_mov_b32 s58, 524288
    s_mov_b32 s59, 0x20000
    s_mov_b32 s62, 1409024
    s_mov_b32 s63, 0x20000
    s_mov_b32 s66, 1409024
    s_mov_b32 s67, 0x20000
    s_mov_b32 s70, 1409024
    s_mov_b32 s71, 0x20000
    s_mov_b32 s82, 2097152
    s_mov_b32 s83, 0x20000
    s_sub_u32 s11, s6, 24
    s_cmp_ge_u32 s6, 24
    s_cselect_b32 s11, s11, s6
    s_lshr_b32 s12, s11, 2
    s_lshl_b32 s12, s12, 3
    s_add_u32 s12, s12, s3
    s_lshl_b32 s12, s12, 2
    s_and_b32 s11, s11, 3
    s_add_u32 s14, s12, s11
    v_lshrrev_b32 v6, 1, v0
    v_and_b32 v6, 31, v6
    s_lshl_b32 s11, s5, 7
    v_add_u32 v6, s11, v6
    v_lshlrev_b32 v10, 1, v6
    v_mul_u32_u24 v11, 6144, v6
    v_and_b32 v9, 1, v0
    v_lshl_add_u32 v11, v9, 4, v11
    s_lshl_b32 s35, s14, 5
    s_lshr_b32 s11, s3, 1
    s_lshr_b32 s13, s6, 2
    s_lshl_b32 s8, s11, 3
    s_add_u32 s8, s8, s13
    s_and_b32 s29, s13, 3
    s_add_u32 s11, s29, 0
    s_and_b32 s11, s11, 3
    s_lshl_b32 s16, s11, 8
    s_add_u32 s11, s29, 1
    s_and_b32 s11, s11, 3
    s_lshl_b32 s17, s11, 8
    s_add_u32 s11, s29, 2
    s_and_b32 s11, s11, 3
    s_lshl_b32 s18, s11, 8
    s_add_u32 s11, s29, 3
    s_and_b32 s11, s11, 3
    s_lshl_b32 s19, s11, 8
    s_lshl_b32 s11, s8, 6
    s_lshl_b32 s12, s5, 4
    s_add_u32 s11, s11, s12
    s_add_u32 s13, s6, 0
    s_and_b32 s13, s13, 3
    s_lshl_b32 s13, s13, 2
    v_add_u32 v16, s13, v2
    v_add_u32 v76, s11, v16
    v_lshlrev_b32 v76, 10, v76
    v_lshl_add_u32 v76, v3, 4, v76
    s_add_u32 s13, s6, 1
    s_and_b32 s13, s13, 3
    s_lshl_b32 s13, s13, 2
    v_add_u32 v17, s13, v2
    v_add_u32 v77, s11, v17
    v_lshlrev_b32 v77, 10, v77
    v_lshl_add_u32 v77, v3, 4, v77
    s_add_u32 s13, s6, 2
    s_and_b32 s13, s13, 3
    s_lshl_b32 s13, s13, 2
    v_add_u32 v18, s13, v2
    v_add_u32 v78, s11, v18
    v_lshlrev_b32 v78, 10, v78
    v_lshl_add_u32 v78, v3, 4, v78
    s_add_u32 s13, s6, 3
    s_and_b32 s13, s13, 3
    s_lshl_b32 s13, s13, 2
    v_add_u32 v19, s13, v2
    v_add_u32 v79, s11, v19
    v_lshlrev_b32 v79, 10, v79
    v_lshl_add_u32 v79, v3, 4, v79
    s_waitcnt lgkmcnt(0)
    buffer_load_ushort v48, v10, s[72:75], 0 offen offset:0
    buffer_load_ushort v49, v10, s[72:75], 0 offen offset:64
    buffer_load_ushort v50, v10, s[72:75], 0 offen offset:128
    buffer_load_ushort v51, v10, s[72:75], 0 offen offset:192
    s_add_u32 s12, s35, 0
    buffer_load_dwordx4 v[32:35], v11, s[76:79], s12 offen
    s_add_u32 s12, s35, 196608
    buffer_load_dwordx4 v[36:39], v11, s[76:79], s12 offen
    s_add_u32 s12, s35, 393216
    buffer_load_dwordx4 v[40:43], v11, s[76:79], s12 offen
    s_add_u32 s12, s35, 589824
    buffer_load_dwordx4 v[44:47], v11, s[76:79], s12 offen
    s_load_dword s4, s[84:85], 0
    s_and_b32 s12, s3, 1
    s_and_b32 s13, s6, 3
    s_lshl_b32 s7, s12, 2
    s_add_u32 s7, s7, s13
    s_and_b32 s12, s3, 3
    s_lshl_b32 s39, s12, 2
    s_add_u32 s39, s39, s13
    s_lshr_b32 s13, s6, 2
    s_lshr_b32 s11, s3, 2
    s_lshl_b32 s38, s11, 3
    s_add_u32 s38, s38, s13
    s_lshr_b32 s13, s6, 4
    s_lshl_b32 s36, s3, 1
    s_add_u32 s36, s36, s13
    s_and_b32 s37, s6, 15
    s_and_b32 s9, s6, 7
    s_mul_i32 s20, s16, 1536
    s_lshl_b32 s24, s16, 1
    s_mul_i32 s21, s17, 1536
    s_lshl_b32 s25, s17, 1
    s_mul_i32 s22, s18, 1536
    s_lshl_b32 s26, s18, 1
    s_mul_i32 s23, s19, 1536
    s_lshl_b32 s27, s19, 1
    s_lshl_b32 s28, s5, 12
    s_mov_b32 s88, 0x7060500
    s_mov_b32 s89, 0x7060501
    s_mov_b32 s90, 0x7060502
    s_mov_b32 s91, 0x7060503
    s_mov_b32 s92, 0x0c0c0400
    s_mov_b32 s93, 0x04000c0c
    s_mov_b32 s94, 0x3fb8aa3b
    s_mov_b32 s95, 0x3fb8aa3b
    s_mov_b32 s96, 0xbfb8aa3b
    s_mov_b32 s97, 0xbfb8aa3b
    s_mov_b32 s98, 0xffff0000
    s_mov_b32 s99, 0x07060302
    s_mov_b32 s3, 0x05040100
    v_cmp_eq_u32 vcc, 0, v0
    v_mov_b32 v23, 2147483632
    s_nop 0
    v_cndmask_b32 v23, v23, 0, vcc
    s_mul_i32 s11, s5, 98304
    s_lshl_b32 s12, s7, 7
    s_add_u32 s11, s11, s12
    v_lshrrev_b32 v6, 3, v1
    v_bfe_u32 v7, v1, 4, 1
    v_bfe_u32 v8, v1, 1, 2
    v_xor_b32 v8, v8, v7
    v_and_b32 v9, 1, v1
    v_lshlrev_b32 v9, 4, v9
    v_lshl_add_u32 v9, v8, 5, v9
    v_mul_u32_u24 v6, 3072, v6
    v_add_u32 v6, s11, v6
    v_add_u32 v24, v6, v9
    v_xor_b32 v9, 64, v9
    v_add_u32 v25, v6, v9
    v_add_u32 v25, 23552, v25
    v_add_u32 v26, 47104, v24
    v_add_u32 v27, 47104, v25
    v_bfe_u32 v6, v1, 2, 2
    v_lshl_add_u32 v6, v2, 3, v6
    v_lshlrev_b32 v6, 7, v6
    v_bfe_u32 v7, v1, 3, 2
    v_xor_b32 v7, s5, v7
    v_lshl_add_u32 v6, v7, 5, v6
    v_and_b32 v7, 3, v1
    v_lshl_add_u32 v28, v7, 3, v6
    v_add_u32 v29, 49152, v28
    v_add_u32 v30, 98304, v28
    v_xor_b32 v6, v3, v16
    v_lshlrev_b32 v6, 4, v6
    v_lshl_add_u32 v6, v16, 8, v6
    v_add_u32 v16, s28, v6
    v_xor_b32 v6, v3, v17
    v_lshlrev_b32 v6, 4, v6
    v_lshl_add_u32 v6, v17, 8, v6
    v_add_u32 v17, s28, v6
    v_xor_b32 v6, v3, v18
    v_lshlrev_b32 v6, 4, v6
    v_lshl_add_u32 v6, v18, 8, v6
    v_add_u32 v18, s28, v6
    v_xor_b32 v6, v3, v19
    v_lshlrev_b32 v6, 4, v6
    v_lshl_add_u32 v6, v19, 8, v6
    v_add_u32 v19, s28, v6
    v_lshlrev_b32 v20, 4, v3
    v_add_u32 v20, 147456, v20
    v_add_u32 v6, 0, v2
    v_xor_b32 v6, v6, v3
    v_lshlrev_b32 v6, 4, v6
    v_lshl_add_u32 v12, v3, 8, v6
    v_add_u32 v6, 4, v2
    v_xor_b32 v6, v6, v3
    v_lshlrev_b32 v6, 4, v6
    v_lshl_add_u32 v13, v3, 8, v6
    v_add_u32 v6, 8, v2
    v_xor_b32 v6, v6, v3
    v_lshlrev_b32 v6, 4, v6
    v_lshl_add_u32 v14, v3, 8, v6
    v_add_u32 v6, 12, v2
    v_xor_b32 v6, v6, v3
    v_lshlrev_b32 v6, 4, v6
    v_lshl_add_u32 v15, v3, 8, v6
    v_add_u32 v103, 0, v1
    v_mul_u32_u24 v104, 5462, v103
    v_lshrrev_b32 v104, 16, v104
    v_mul_u32_u24 v105, 12, v104
    v_sub_u32 v105, v103, v105
    v_bfe_u32 v106, v104, 2, 1
    v_lshlrev_b32 v106, 1, v106
    v_xor_b32 v105, v105, v106
    v_mul_u32_u24 v104, 2752, v104
    v_lshl_add_u32 v100, v105, 4, v104
    v_add_u32 v103, 64, v1
    v_mul_u32_u24 v104, 5462, v103
    v_lshrrev_b32 v104, 16, v104
    v_mul_u32_u24 v105, 12, v104
    v_sub_u32 v105, v103, v105
    v_bfe_u32 v106, v104, 2, 1
    v_lshlrev_b32 v106, 1, v106
    v_xor_b32 v105, v105, v106
    v_mul_u32_u24 v104, 2752, v104
    v_lshl_add_u32 v101, v105, 4, v104
    v_subrev_u32 v101, 1024, v101
    v_add_u32 v103, 128, v1
    v_mul_u32_u24 v104, 5462, v103
    v_lshrrev_b32 v104, 16, v104
    v_mul_u32_u24 v105, 12, v104
    v_sub_u32 v105, v103, v105
    v_bfe_u32 v106, v104, 2, 1
    v_lshlrev_b32 v106, 1, v106
    v_xor_b32 v105, v105, v106
    v_mul_u32_u24 v104, 2752, v104
    v_lshl_add_u32 v102, v105, 4, v104
    v_subrev_u32 v102, 2048, v102
    v_accvgpr_write_b32 a240, v100
    v_accvgpr_write_b32 a241, v101
    v_accvgpr_write_b32 a242, v102
    v_lshrrev_b32 v82, 3, v1
    v_bfe_u32 v83, v1, 4, 2
    v_bfe_u32 v84, v1, 1, 2
    v_xor_b32 v84, v84, v83
    v_and_b32 v85, 1, v1
    v_lshlrev_b32 v85, 4, v85
    v_lshl_add_u32 v85, v84, 5, v85
    v_mul_u32_u24 v82, 1024, v82
    v_add_u32 v100, v82, v85
    v_add_u32 v101, 7168, v100
    v_add_u32 v102, 14336, v100
    v_add_u32 v103, 14336, v101
    v_accvgpr_write_b32 a243, v100
    v_accvgpr_write_b32 a244, v101
    v_accvgpr_write_b32 a245, v102
    v_accvgpr_write_b32 a246, v103
    v_lshrrev_b32 v104, 2, v1
    v_lshlrev_b32 v104, 7, v104
    v_bfe_u32 v105, v1, 3, 2
    s_and_b32 s43, s5, 2
    v_xor_b32 v105, s43, v105
    v_lshl_add_u32 v104, v105, 5, v104
    v_and_b32 v105, 3, v1
    v_lshl_add_u32 v104, v105, 3, v104
    s_lshl_b32 s43, s5, 14
    s_add_u32 s43, s43, 65536
    v_add_u32 v104, s43, v104
    v_accvgpr_write_b32 a247, v104
    s_add_u32 s12, s28, 131072
    v_and_b32 v84, 31, v1
    v_lshlrev_b32 v84, 6, v84
    v_lshrrev_b32 v85, 5, v1
    v_lshlrev_b32 v85, 1, v85
    v_bfe_u32 v86, v1, 1, 2
    v_xor_b32 v85, v85, v86
    v_lshl_add_u32 v84, v85, 4, v84
    v_add_u32 v84, s12, v84
    v_xor_b32 v93, 16, v84
    v_lshrrev_b32 v85, 2, v1
    v_lshlrev_b32 v85, 6, v85
    v_bfe_u32 v86, v1, 1, 1
    v_bfe_u32 v87, v1, 3, 2
    v_xor_b32 v86, v86, v87
    v_lshl_add_u32 v85, v86, 4, v85
    v_and_b32 v86, 1, v1
    v_lshl_add_u32 v85, v86, 3, v85
    v_add_u32 v85, s12, v85
    v_xor_b32 v86, 32, v85
    v_mov_b32 v94, 0x3f803f80
    v_mov_b32 v94, 0x3f803f80
    v_mov_b32 v94, 0x3f803f80
    v_mov_b32 v94, 0x3f803f80
    v_accvgpr_write_b32 a248, v84
    v_accvgpr_write_b32 a249, v85
    s_and_b32 s11, s2, 7
    s_lshl_b32 s12, s11, 4
    s_add_u32 s12, s12, 2048
    s_lshl_b32 s11, s11, 2
    s_add_u32 s11, s11, s5
    s_lshl_b32 s11, s11, 6
    v_and_b32 v90, 7, v1
    v_lshlrev_b32 v91, 4, v90
    v_add_u32 v91, s11, v91
    v_mov_b32 v92, s12
    v_cmp_gt_u32 vcc, 4, v90
    s_nop 1
    v_cndmask_b32 v91, v92, v91, vcc
    v_lshrrev_b32 v92, 3, v1
    v_mul_u32_u24 v92, 2176, v92
    v_add_u32 v92, v92, v91
    s_mul_i32 s29, s6, 69632
    s_add_u32 s29, s29, 1048576
    s_mul_i32 s30, s6, 2176
    s_add_u32 s30, s30, 131072
    s_mov_b32 s31, 0xffffff00
    v_cmp_gt_u32 vcc, 5, v1
    v_mov_b32 v90, 2147483632
    s_nop 0
    v_cndmask_b32 v91, v90, v91, vcc
    v_accvgpr_write_b32 a250, v91
    v_accvgpr_write_b32 a251, v92
    v_and_b32 v6, 1, v1
    v_lshlrev_b32 v6, 5, v6
    v_lshl_add_u32 v6, v2, 3, v6
    s_lshl_b32 s11, s5, 6
    s_add_u32 s11, s11, 159744
    v_add_u32 v6, s11, v6
    v_lshlrev_b32 v7, 3, v0
    v_add_u32 v7, 160768, v7
    v_and_b32 v8, 14, v1
    v_cmp_eq_u32 vcc, 0, v8
    s_nop 1
    v_cndmask_b32 v6, v7, v6, vcc
    v_and_b32 v7, 3, v1
    s_waitcnt vmcnt(4)
    v_lshlrev_b32 v48, 16, v48
    v_lshlrev_b32 v49, 16, v49
    v_lshlrev_b32 v50, 16, v50
    v_lshlrev_b32 v51, 16, v51
    v_mul_f32 v52, s96, v48
    v_mul_f32 v53, s96, v49
    v_mul_f32 v54, s96, v50
    v_mul_f32 v55, s96, v51
    v_min_f32 v52, 0x42f00000, v52
    v_min_f32 v53, 0x42f00000, v53
    v_min_f32 v54, 0x42f00000, v54
    v_min_f32 v55, 0x42f00000, v55
    v_exp_f32 v52, v52
    v_exp_f32 v53, v53
    v_exp_f32 v54, v54
    v_exp_f32 v55, v55
    v_add_f32 v52, 1.0, v52
    v_add_f32 v53, 1.0, v53
    v_add_f32 v54, 1.0, v54
    v_add_f32 v55, 1.0, v55
    v_rcp_f32 v56, v52
    v_rcp_f32 v57, v53
    v_rcp_f32 v58, v54
    v_rcp_f32 v59, v55
    v_mul_f32 v72, v48, v56
    v_mul_f32 v73, v49, v57
    buffer_load_dwordx4 v[192:195], v76, s[44:47], s16 offen
    v_mul_f32 v74, v50, v58
    v_mul_f32 v75, v51, v59
    v_fma_f32 v48, -v72, v52, v48
    v_fma_f32 v49, -v73, v53, v49
    v_fma_f32 v50, -v74, v54, v50
    v_fma_f32 v51, -v75, v55, v51
    v_fma_f32 v48, v48, v56, v72
    buffer_load_dwordx4 v[196:199], v76, s[44:47], s17 offen
    v_fma_f32 v49, v49, v57, v73
    v_fma_f32 v50, v50, v58, v74
    v_fma_f32 v51, v51, v59, v75
    v_cvt_pk_bf16_f32 v52, v48, v49
    v_cvt_pk_bf16_f32 v53, v50, v51
    v_lshlrev_b32 v48, 16, v52
    buffer_load_dwordx4 v[200:203], v76, s[44:47], s18 offen
    v_and_b32 v49, s98, v52
    v_lshlrev_b32 v50, 16, v53
    v_and_b32 v51, s98, v53
    s_waitcnt vmcnt(6)
    v_lshlrev_b32 v52, 16, v32
    v_and_b32 v53, s98, v32
    buffer_load_dwordx4 v[204:207], v76, s[44:47], s19 offen
    v_mul_f32 v64, v48, v52
    v_mul_f32 v65, v48, v53
    v_lshlrev_b32 v52, 16, v33
    v_and_b32 v53, s98, v33
    v_mul_f32 v66, v48, v52
    v_mul_f32 v67, v48, v53
    buffer_load_dwordx4 v[208:211], v77, s[44:47], s16 offen
    v_lshlrev_b32 v52, 16, v34
    v_and_b32 v53, s98, v34
    v_mul_f32 v68, v48, v52
    v_mul_f32 v69, v48, v53
    v_lshlrev_b32 v52, 16, v35
    v_and_b32 v53, s98, v35
    v_mul_f32 v70, v48, v52
    buffer_load_dwordx4 v[212:215], v77, s[44:47], s17 offen
    v_mul_f32 v71, v48, v53
    s_waitcnt vmcnt(8)
    v_lshlrev_b32 v52, 16, v36
    v_and_b32 v53, s98, v36
    v_fmac_f32 v64, v49, v52
    v_fmac_f32 v65, v49, v53
    buffer_load_dwordx4 v[216:219], v77, s[44:47], s18 offen
    v_lshlrev_b32 v52, 16, v37
    v_and_b32 v53, s98, v37
    v_fmac_f32 v66, v49, v52
    v_fmac_f32 v67, v49, v53
    v_lshlrev_b32 v52, 16, v38
    v_and_b32 v53, s98, v38
    buffer_load_dwordx4 v[220:223], v77, s[44:47], s19 offen
    v_fmac_f32 v68, v49, v52
    v_fmac_f32 v69, v49, v53
    v_lshlrev_b32 v52, 16, v39
    v_and_b32 v53, s98, v39
    v_fmac_f32 v70, v49, v52
    v_fmac_f32 v71, v49, v53
    buffer_load_dwordx4 v[224:227], v78, s[44:47], s16 offen
    s_waitcnt vmcnt(10)
    v_lshlrev_b32 v52, 16, v40
    v_and_b32 v53, s98, v40
    v_fmac_f32 v64, v50, v52
    v_fmac_f32 v65, v50, v53
    v_lshlrev_b32 v52, 16, v41
    v_and_b32 v53, s98, v41
    buffer_load_dwordx4 v[228:231], v78, s[44:47], s17 offen
    v_fmac_f32 v66, v50, v52
    v_fmac_f32 v67, v50, v53
    v_lshlrev_b32 v52, 16, v42
    v_and_b32 v53, s98, v42
    v_fmac_f32 v68, v50, v52
    v_fmac_f32 v69, v50, v53
    buffer_load_dwordx4 v[232:235], v78, s[44:47], s18 offen
    v_lshlrev_b32 v52, 16, v43
    v_and_b32 v53, s98, v43
    v_fmac_f32 v70, v50, v52
    v_fmac_f32 v71, v50, v53
    s_waitcnt vmcnt(11)
    v_lshlrev_b32 v52, 16, v44
    buffer_load_dwordx4 v[236:239], v78, s[44:47], s19 offen
    v_and_b32 v53, s98, v44
    v_fmac_f32 v64, v51, v52
    v_fmac_f32 v65, v51, v53
    v_lshlrev_b32 v52, 16, v45
    v_and_b32 v53, s98, v45
    v_fmac_f32 v66, v51, v52
    buffer_load_dwordx4 v[240:243], v79, s[44:47], s16 offen
    v_fmac_f32 v67, v51, v53
    v_lshlrev_b32 v52, 16, v46
    v_and_b32 v53, s98, v46
    v_fmac_f32 v68, v51, v52
    v_fmac_f32 v69, v51, v53
    v_lshlrev_b32 v52, 16, v47
    v_and_b32 v53, s98, v47
    buffer_load_dwordx4 v[244:247], v79, s[44:47], s17 offen
    v_fmac_f32 v70, v51, v52
    v_fmac_f32 v71, v51, v53
    v_permlane32_swap_b32 v64, v68
    v_permlane32_swap_b32 v65, v69
    v_permlane32_swap_b32 v66, v70
    v_permlane32_swap_b32 v67, v71
    buffer_load_dwordx4 v[248:251], v79, s[44:47], s18 offen
    v_add_f32 v64, v64, v68
    v_add_f32 v65, v65, v69
    v_add_f32 v66, v66, v70
    v_add_f32 v67, v67, v71
    s_nop 0
    v_permlane16_swap_b32 v64, v66
    v_permlane16_swap_b32 v65, v67
    buffer_load_dwordx4 v[252:255], v79, s[44:47], s19 offen
    v_add_f32 v64, v64, v66
    v_add_f32 v65, v65, v67
    s_nop 0
    v_add_f32_dpp v64, v64, v64 row_ror:8 row_mask:0xf bank_mask:0xf
    v_add_f32_dpp v65, v65, v65 row_ror:8 row_mask:0xf bank_mask:0xf
    s_nop 0
    v_add_f32_dpp v64, v64, v64 row_ror:4 row_mask:0xf bank_mask:0xf
    v_add_f32_dpp v65, v65, v65 row_ror:4 row_mask:0xf bank_mask:0xf
    v_and_b32 v10, 7, v1
    v_add_f32_dpp v64, v64, v64 row_ror:2 row_mask:0xf bank_mask:0xf
    v_lshlrev_b32 v10, 21, v10
    buffer_load_dword a255, v10, s[84:87], 0 offen offset:64
    v_add_f32_dpp v65, v65, v65 row_ror:2 row_mask:0xf bank_mask:0xf
    v_and_b32 v10, 1, v1
    v_lshlrev_b32 v10, 20, v10
    ds_write_b64 v6, v[64:65]
    buffer_load_dword a255, v10, s[56:59], 0 offen
    buffer_load_dword a255, v10, s[60:63], 0 offen
    v_lshlrev_b32 v7, 4, v7
    buffer_load_dword a255, v10, s[64:67], 0 offen
    buffer_load_dword a255, v10, s[68:71], 0 offen
    v_add_u32 v6, 159744, v7
    buffer_load_dword a255, v10, s[80:83], 0 offen
    s_waitcnt lgkmcnt(0)
    s_barrier
    ds_read_b128 v[32:35], v6 offset:0
    ds_read_b128 v[36:39], v6 offset:64
    ds_read_b128 v[40:43], v6 offset:128
    ds_read_b128 v[44:47], v6 offset:192
    s_add_u32 s4, s4, 0x9e3779b1
    v_mov_b32 v4, s4
    s_lshr_b32 s11, s14, 5
    s_cmp_eq_u32 s11, 1
    s_cselect_b32 s12, 1.0, 0
    s_cmp_eq_u32 s11, 4
    s_cselect_b32 s12, 1.0, s12
    v_cmp_gt_u32 vcc, 4, v0
    v_mov_b32 v6, 2147483632
    s_nop 0
    v_cndmask_b32 v7, v6, v7, vcc
    s_lshl_b32 s11, s14, 6
    s_add_u32 s11, s11, 65536
    s_waitcnt lgkmcnt(0)
    v_pk_add_f32 v[32:33], v[32:33], v[36:37]
    v_pk_add_f32 v[40:41], v[40:41], v[44:45]
    v_pk_add_f32 v[34:35], v[34:35], v[38:39]
    v_pk_add_f32 v[42:43], v[42:43], v[46:47]
    v_pk_add_f32 v[32:33], v[32:33], v[40:41]
    v_pk_add_f32 v[34:35], v[34:35], v[42:43]
    v_cvt_pk_bf16_f32 v36, v32, v33
    v_cvt_pk_bf16_f32 v37, v34, v35
    v_lshlrev_b32 v32, 16, v36
    v_and_b32 v33, s98, v36
    v_lshlrev_b32 v34, 16, v37
    v_and_b32 v35, s98, v37
    v_add_f32 v32, s12, v32
    v_add_f32 v33, s12, v33
    v_add_f32 v34, s12, v34
    v_add_f32 v35, s12, v35
    v_cvt_pk_bf16_f32 v36, v32, v33
    v_cvt_pk_bf16_f32 v37, v34, v35
    v_perm_b32 v32, v36, v4, s3
    v_perm_b32 v33, v36, v4, s99
    v_perm_b32 v34, v37, v4, s3
    v_perm_b32 v35, v37, v4, s99
    buffer_store_dwordx4 v[32:35], v7, s[84:87], s11 offen sc1
    s_lshl_b32 s34, s7, 2
    s_add_u32 s34, s34, s5
    s_lshl_b32 s11, s34, 9
    v_bfe_u32 v6, v1, 3, 2
    v_and_b32 v7, 3, v1
    v_lshl_add_u32 v6, v6, 2, v7
    v_lshlrev_b32 v6, 1, v6
    v_lshrrev_b32 v7, 5, v1
    v_lshl_add_u32 v6, v7, 8, v6
    buffer_load_ushort v44, v6, s[52:55], s11 offen offset:0
    buffer_load_ushort v45, v6, s[52:55], s11 offen offset:32
    buffer_load_ushort v46, v6, s[52:55], s11 offen offset:64
    buffer_load_ushort v47, v6, s[52:55], s11 offen offset:96
    buffer_load_ushort v48, v6, s[52:55], s11 offen offset:128
    buffer_load_ushort v49, v6, s[52:55], s11 offen offset:160
    buffer_load_ushort v50, v6, s[52:55], s11 offen offset:192
    buffer_load_ushort v51, v6, s[52:55], s11 offen offset:224
    s_waitcnt vmcnt(23)
    s_add_u32 m0, s28, 0
    s_add_u32 s35, s20, 1024
    v_lshlrev_b32 v64, 16, v192
    buffer_load_dwordx4 v24, s[48:51], s35 offen offset:0 lds
    v_lshlrev_b32 v96, 16, v208
    v_and_b32 v65, s98, v192
    v_and_b32 v97, s98, v208
    v_lshlrev_b32 v66, 16, v193
    v_lshlrev_b32 v98, 16, v209
    v_and_b32 v67, s98, v193
    v_and_b32 v99, s98, v209
    v_lshlrev_b32 v68, 16, v194
    v_lshlrev_b32 v100, 16, v210
    v_and_b32 v69, s98, v194
    v_and_b32 v101, s98, v210
    v_lshlrev_b32 v70, 16, v195
    v_lshlrev_b32 v102, 16, v211
    v_and_b32 v71, s98, v195
    v_and_b32 v103, s98, v211
    v_lshlrev_b32 v72, 16, v196
    buffer_load_dwordx4 v25, s[48:51], s35 offen offset:1024 lds
    v_lshlrev_b32 v104, 16, v212
    v_and_b32 v73, s98, v196
    v_and_b32 v105, s98, v212
    v_lshlrev_b32 v74, 16, v197
    v_lshlrev_b32 v106, 16, v213
    v_and_b32 v75, s98, v197
    v_and_b32 v107, s98, v213
    v_lshlrev_b32 v76, 16, v198
    v_lshlrev_b32 v108, 16, v214
    v_and_b32 v77, s98, v198
    v_and_b32 v109, s98, v214
    v_lshlrev_b32 v78, 16, v199
    v_lshlrev_b32 v110, 16, v215
    v_and_b32 v79, s98, v199
    v_and_b32 v111, s98, v215
    v_lshlrev_b32 v80, 16, v200
    v_lshlrev_b32 v112, 16, v216
    buffer_load_dwordx4 v26, s[48:51], s35 offen offset:2048 lds
    v_and_b32 v81, s98, v200
    v_and_b32 v113, s98, v216
    v_lshlrev_b32 v82, 16, v201
    v_lshlrev_b32 v114, 16, v217
    v_and_b32 v83, s98, v201
    v_and_b32 v115, s98, v217
    v_lshlrev_b32 v84, 16, v202
    v_lshlrev_b32 v116, 16, v218
    v_and_b32 v85, s98, v202
    v_and_b32 v117, s98, v218
    v_lshlrev_b32 v86, 16, v203
    v_lshlrev_b32 v118, 16, v219
    v_and_b32 v87, s98, v203
    v_and_b32 v119, s98, v219
    v_lshlrev_b32 v88, 16, v204
    v_lshlrev_b32 v120, 16, v220
    buffer_load_dwordx4 v27, s[48:51], s35 offen offset:3072 lds
    v_and_b32 v89, s98, v204
    v_and_b32 v121, s98, v220
    v_lshlrev_b32 v90, 16, v205
    v_lshlrev_b32 v122, 16, v221
    v_and_b32 v91, s98, v205
    v_and_b32 v123, s98, v221
    v_lshlrev_b32 v92, 16, v206
    v_lshlrev_b32 v124, 16, v222
    v_and_b32 v93, s98, v206
    v_and_b32 v125, s98, v222
    v_lshlrev_b32 v94, 16, v207
    v_lshlrev_b32 v126, 16, v223
    v_and_b32 v95, s98, v207
    v_and_b32 v127, s98, v223
    v_pk_add_f32 v[32:33], v[64:65], v[66:67]
    v_pk_add_f32 v[54:55], v[96:97], v[98:99]
    s_add_u32 m0, s28, 16384
    v_pk_add_f32 v[34:35], v[68:69], v[70:71]
    s_add_u32 s35, s20, 2048
    buffer_load_dwordx4 v24, s[48:51], s35 offen offset:0 lds
    v_pk_add_f32 v[56:57], v[100:101], v[102:103]
    v_pk_add_f32 v[32:33], v[32:33], v[72:73]
    v_pk_add_f32 v[54:55], v[54:55], v[104:105]
    v_pk_add_f32 v[34:35], v[34:35], v[74:75]
    v_pk_add_f32 v[56:57], v[56:57], v[106:107]
    v_pk_add_f32 v[32:33], v[32:33], v[76:77]
    v_pk_add_f32 v[54:55], v[54:55], v[108:109]
    v_pk_add_f32 v[34:35], v[34:35], v[78:79]
    v_pk_add_f32 v[56:57], v[56:57], v[110:111]
    v_pk_add_f32 v[32:33], v[32:33], v[80:81]
    v_pk_add_f32 v[54:55], v[54:55], v[112:113]
    v_pk_add_f32 v[34:35], v[34:35], v[82:83]
    v_pk_add_f32 v[56:57], v[56:57], v[114:115]
    v_pk_add_f32 v[32:33], v[32:33], v[84:85]
    v_pk_add_f32 v[54:55], v[54:55], v[116:117]
    v_pk_add_f32 v[34:35], v[34:35], v[86:87]
    v_pk_add_f32 v[56:57], v[56:57], v[118:119]
    buffer_load_dwordx4 v25, s[48:51], s35 offen offset:1024 lds
    v_pk_add_f32 v[32:33], v[32:33], v[88:89]
    v_pk_add_f32 v[54:55], v[54:55], v[120:121]
    v_pk_add_f32 v[34:35], v[34:35], v[90:91]
    v_pk_add_f32 v[56:57], v[56:57], v[122:123]
    v_pk_add_f32 v[32:33], v[32:33], v[92:93]
    v_pk_add_f32 v[54:55], v[54:55], v[124:125]
    v_pk_add_f32 v[34:35], v[34:35], v[94:95]
    v_pk_add_f32 v[56:57], v[56:57], v[126:127]
    v_pk_add_f32 v[32:33], v[32:33], v[34:35]
    v_pk_add_f32 v[54:55], v[54:55], v[56:57]
    v_add_f32 v32, v32, v33
    v_add_f32 v54, v54, v55
    s_nop 0
    v_add_f32_dpp v32, v32, v32 row_ror:8 row_mask:0xf bank_mask:0xf
    v_add_f32_dpp v54, v54, v54 row_ror:8 row_mask:0xf bank_mask:0xf
    s_nop 0
    v_add_f32_dpp v32, v32, v32 row_ror:4 row_mask:0xf bank_mask:0xf
    v_add_f32_dpp v54, v54, v54 row_ror:4 row_mask:0xf bank_mask:0xf
    buffer_load_dwordx4 v26, s[48:51], s35 offen offset:2048 lds
    v_add_f32_dpp v32, v32, v32 row_ror:2 row_mask:0xf bank_mask:0xf
    v_add_f32_dpp v54, v54, v54 row_ror:2 row_mask:0xf bank_mask:0xf
    s_nop 0
    v_add_f32_dpp v32, v32, v32 row_ror:1 row_mask:0xf bank_mask:0xf
    v_add_f32_dpp v54, v54, v54 row_ror:1 row_mask:0xf bank_mask:0xf
    v_mul_f32 v32, 0xbb000000, v32
    v_mul_f32 v54, 0xbb000000, v54
    v_pk_add_f32 v[64:65], v[64:65], v[32:33] op_sel_hi:[1,0]
    v_pk_add_f32 v[96:97], v[96:97], v[54:55] op_sel_hi:[1,0]
    v_pk_add_f32 v[66:67], v[66:67], v[32:33] op_sel_hi:[1,0]
    v_pk_add_f32 v[98:99], v[98:99], v[54:55] op_sel_hi:[1,0]
    v_pk_add_f32 v[68:69], v[68:69], v[32:33] op_sel_hi:[1,0]
    v_pk_add_f32 v[100:101], v[100:101], v[54:55] op_sel_hi:[1,0]
    v_pk_add_f32 v[70:71], v[70:71], v[32:33] op_sel_hi:[1,0]
    v_pk_add_f32 v[102:103], v[102:103], v[54:55] op_sel_hi:[1,0]
    v_pk_add_f32 v[72:73], v[72:73], v[32:33] op_sel_hi:[1,0]
    v_pk_add_f32 v[104:105], v[104:105], v[54:55] op_sel_hi:[1,0]
    buffer_load_dwordx4 v27, s[48:51], s35 offen offset:3072 lds
    v_pk_add_f32 v[74:75], v[74:75], v[32:33] op_sel_hi:[1,0]
    v_pk_add_f32 v[106:107], v[106:107], v[54:55] op_sel_hi:[1,0]
    v_pk_add_f32 v[76:77], v[76:77], v[32:33] op_sel_hi:[1,0]
    v_pk_add_f32 v[108:109], v[108:109], v[54:55] op_sel_hi:[1,0]
    v_pk_add_f32 v[78:79], v[78:79], v[32:33] op_sel_hi:[1,0]
    v_pk_add_f32 v[110:111], v[110:111], v[54:55] op_sel_hi:[1,0]
    v_pk_add_f32 v[80:81], v[80:81], v[32:33] op_sel_hi:[1,0]
    v_pk_add_f32 v[112:113], v[112:113], v[54:55] op_sel_hi:[1,0]
    v_pk_add_f32 v[82:83], v[82:83], v[32:33] op_sel_hi:[1,0]
    v_pk_add_f32 v[114:115], v[114:115], v[54:55] op_sel_hi:[1,0]
    v_pk_add_f32 v[84:85], v[84:85], v[32:33] op_sel_hi:[1,0]
    v_pk_add_f32 v[116:117], v[116:117], v[54:55] op_sel_hi:[1,0]
    v_pk_add_f32 v[86:87], v[86:87], v[32:33] op_sel_hi:[1,0]
    v_pk_add_f32 v[118:119], v[118:119], v[54:55] op_sel_hi:[1,0]
    v_pk_add_f32 v[88:89], v[88:89], v[32:33] op_sel_hi:[1,0]
    v_pk_add_f32 v[120:121], v[120:121], v[54:55] op_sel_hi:[1,0]
    s_add_u32 m0, s28, 32768
    v_pk_add_f32 v[90:91], v[90:91], v[32:33] op_sel_hi:[1,0]
    s_add_u32 s35, s20, 0
    v_pk_add_f32 v[122:123], v[122:123], v[54:55] op_sel_hi:[1,0]
    buffer_load_dwordx4 v24, s[48:51], s35 offen offset:0 lds
    v_pk_add_f32 v[92:93], v[92:93], v[32:33] op_sel_hi:[1,0]
    v_pk_add_f32 v[124:125], v[124:125], v[54:55] op_sel_hi:[1,0]
    v_pk_add_f32 v[94:95], v[94:95], v[32:33] op_sel_hi:[1,0]
    v_pk_add_f32 v[126:127], v[126:127], v[54:55] op_sel_hi:[1,0]
    v_pk_mul_f32 v[34:35], v[64:65], v[64:65]
    v_pk_mul_f32 v[56:57], v[96:97], v[96:97]
    v_pk_mul_f32 v[36:37], v[66:67], v[66:67]
    v_pk_mul_f32 v[58:59], v[98:99], v[98:99]
    v_pk_fma_f32 v[34:35], v[68:69], v[68:69], v[34:35]
    v_pk_fma_f32 v[56:57], v[100:101], v[100:101], v[56:57]
    v_pk_fma_f32 v[36:37], v[70:71], v[70:71], v[36:37]
    v_pk_fma_f32 v[58:59], v[102:103], v[102:103], v[58:59]
    v_pk_fma_f32 v[34:35], v[72:73], v[72:73], v[34:35]
    v_pk_fma_f32 v[56:57], v[104:105], v[104:105], v[56:57]
    v_pk_fma_f32 v[36:37], v[74:75], v[74:75], v[36:37]
    v_pk_fma_f32 v[58:59], v[106:107], v[106:107], v[58:59]
    buffer_load_dwordx4 v25, s[48:51], s35 offen offset:1024 lds
    v_pk_fma_f32 v[34:35], v[76:77], v[76:77], v[34:35]
    v_pk_fma_f32 v[56:57], v[108:109], v[108:109], v[56:57]
    v_pk_fma_f32 v[36:37], v[78:79], v[78:79], v[36:37]
    v_pk_fma_f32 v[58:59], v[110:111], v[110:111], v[58:59]
    v_pk_fma_f32 v[34:35], v[80:81], v[80:81], v[34:35]
    v_pk_fma_f32 v[56:57], v[112:113], v[112:113], v[56:57]
    v_pk_fma_f32 v[36:37], v[82:83], v[82:83], v[36:37]
    v_pk_fma_f32 v[58:59], v[114:115], v[114:115], v[58:59]
    v_pk_fma_f32 v[34:35], v[84:85], v[84:85], v[34:35]
    v_pk_fma_f32 v[56:57], v[116:117], v[116:117], v[56:57]
    v_pk_fma_f32 v[36:37], v[86:87], v[86:87], v[36:37]
    v_pk_fma_f32 v[58:59], v[118:119], v[118:119], v[58:59]
    v_pk_fma_f32 v[34:35], v[88:89], v[88:89], v[34:35]
    v_pk_fma_f32 v[56:57], v[120:121], v[120:121], v[56:57]
    v_pk_fma_f32 v[36:37], v[90:91], v[90:91], v[36:37]
    v_pk_fma_f32 v[58:59], v[122:123], v[122:123], v[58:59]
    buffer_load_dwordx4 v26, s[48:51], s35 offen offset:2048 lds
    v_pk_fma_f32 v[34:35], v[92:93], v[92:93], v[34:35]
    v_pk_fma_f32 v[56:57], v[124:125], v[124:125], v[56:57]
    v_pk_fma_f32 v[36:37], v[94:95], v[94:95], v[36:37]
    v_pk_fma_f32 v[58:59], v[126:127], v[126:127], v[58:59]
    v_pk_add_f32 v[34:35], v[34:35], v[36:37]
    v_pk_add_f32 v[56:57], v[56:57], v[58:59]
    v_add_f32 v34, v34, v35
    v_add_f32 v56, v56, v57
    s_nop 0
    v_add_f32_dpp v34, v34, v34 row_ror:8 row_mask:0xf bank_mask:0xf
    v_add_f32_dpp v56, v56, v56 row_ror:8 row_mask:0xf bank_mask:0xf
    s_nop 0
    v_add_f32_dpp v34, v34, v34 row_ror:4 row_mask:0xf bank_mask:0xf
    v_add_f32_dpp v56, v56, v56 row_ror:4 row_mask:0xf bank_mask:0xf
    s_nop 0
    v_add_f32_dpp v34, v34, v34 row_ror:2 row_mask:0xf bank_mask:0xf
    v_add_f32_dpp v56, v56, v56 row_ror:2 row_mask:0xf bank_mask:0xf
    s_nop 0
    v_add_f32_dpp v34, v34, v34 row_ror:1 row_mask:0xf bank_mask:0xf
    v_add_f32_dpp v56, v56, v56 row_ror:1 row_mask:0xf bank_mask:0xf
    v_mov_b32 v35, 0x3727c5ac
    buffer_load_dwordx4 v27, s[48:51], s35 offen offset:3072 lds
    v_mov_b32 v57, 0x3727c5ac
    v_fmac_f32 v35, 0x3b000000, v34
    v_fmac_f32 v57, 0x3b000000, v56
    v_rsq_f32 v34, v35
    v_rsq_f32 v56, v57
    v_pk_mul_f32 v[64:65], v[64:65], v[34:35] op_sel_hi:[1,0]
    v_pk_mul_f32 v[96:97], v[96:97], v[56:57] op_sel_hi:[1,0]
    v_pk_mul_f32 v[66:67], v[66:67], v[34:35] op_sel_hi:[1,0]
    v_pk_mul_f32 v[98:99], v[98:99], v[56:57] op_sel_hi:[1,0]
    v_pk_mul_f32 v[68:69], v[68:69], v[34:35] op_sel_hi:[1,0]
    v_pk_mul_f32 v[100:101], v[100:101], v[56:57] op_sel_hi:[1,0]
    v_pk_mul_f32 v[70:71], v[70:71], v[34:35] op_sel_hi:[1,0]
    v_pk_mul_f32 v[102:103], v[102:103], v[56:57] op_sel_hi:[1,0]
    v_pk_mul_f32 v[72:73], v[72:73], v[34:35] op_sel_hi:[1,0]
    s_add_u32 m0, s28, 98304
    v_pk_mul_f32 v[104:105], v[104:105], v[56:57] op_sel_hi:[1,0]
    s_add_u32 s35, s21, 1024
    v_pk_mul_f32 v[74:75], v[74:75], v[34:35] op_sel_hi:[1,0]
    buffer_load_dwordx4 v24, s[48:51], s35 offen offset:0 lds
    v_pk_mul_f32 v[106:107], v[106:107], v[56:57] op_sel_hi:[1,0]
    v_pk_mul_f32 v[76:77], v[76:77], v[34:35] op_sel_hi:[1,0]
    v_pk_mul_f32 v[108:109], v[108:109], v[56:57] op_sel_hi:[1,0]
    v_pk_mul_f32 v[78:79], v[78:79], v[34:35] op_sel_hi:[1,0]
    v_pk_mul_f32 v[110:111], v[110:111], v[56:57] op_sel_hi:[1,0]
    v_pk_mul_f32 v[80:81], v[80:81], v[34:35] op_sel_hi:[1,0]
    v_pk_mul_f32 v[112:113], v[112:113], v[56:57] op_sel_hi:[1,0]
    v_pk_mul_f32 v[82:83], v[82:83], v[34:35] op_sel_hi:[1,0]
    v_pk_mul_f32 v[114:115], v[114:115], v[56:57] op_sel_hi:[1,0]
    v_pk_mul_f32 v[84:85], v[84:85], v[34:35] op_sel_hi:[1,0]
    v_pk_mul_f32 v[116:117], v[116:117], v[56:57] op_sel_hi:[1,0]
    v_pk_mul_f32 v[86:87], v[86:87], v[34:35] op_sel_hi:[1,0]
    v_pk_mul_f32 v[118:119], v[118:119], v[56:57] op_sel_hi:[1,0]
    v_pk_mul_f32 v[88:89], v[88:89], v[34:35] op_sel_hi:[1,0]
    v_pk_mul_f32 v[120:121], v[120:121], v[56:57] op_sel_hi:[1,0]
    v_pk_mul_f32 v[90:91], v[90:91], v[34:35] op_sel_hi:[1,0]
    buffer_load_dwordx4 v25, s[48:51], s35 offen offset:1024 lds
    v_pk_mul_f32 v[122:123], v[122:123], v[56:57] op_sel_hi:[1,0]
    v_pk_mul_f32 v[92:93], v[92:93], v[34:35] op_sel_hi:[1,0]
    v_pk_mul_f32 v[124:125], v[124:125], v[56:57] op_sel_hi:[1,0]
    v_pk_mul_f32 v[94:95], v[94:95], v[34:35] op_sel_hi:[1,0]
    v_pk_mul_f32 v[126:127], v[126:127], v[56:57] op_sel_hi:[1,0]
    s_waitcnt vmcnt(29)
    v_lshlrev_b32 v128, 16, v224
    v_lshlrev_b32 v160, 16, v240
    v_and_b32 v129, s98, v224
    v_and_b32 v161, s98, v240
    v_lshlrev_b32 v130, 16, v225
    v_lshlrev_b32 v162, 16, v241
    v_and_b32 v131, s98, v225
    v_and_b32 v163, s98, v241
    v_lshlrev_b32 v132, 16, v226
    v_lshlrev_b32 v164, 16, v242
    buffer_load_dwordx4 v26, s[48:51], s35 offen offset:2048 lds
    v_and_b32 v133, s98, v226
    v_and_b32 v165, s98, v242
    v_lshlrev_b32 v134, 16, v227
    v_lshlrev_b32 v166, 16, v243
    v_and_b32 v135, s98, v227
    v_and_b32 v167, s98, v243
    v_lshlrev_b32 v136, 16, v228
    v_lshlrev_b32 v168, 16, v244
    v_and_b32 v137, s98, v228
    v_and_b32 v169, s98, v244
    v_lshlrev_b32 v138, 16, v229
    v_lshlrev_b32 v170, 16, v245
    v_and_b32 v139, s98, v229
    v_and_b32 v171, s98, v245
    v_lshlrev_b32 v140, 16, v230
    v_lshlrev_b32 v172, 16, v246
    buffer_load_dwordx4 v27, s[48:51], s35 offen offset:3072 lds
    v_and_b32 v141, s98, v230
    v_and_b32 v173, s98, v246
    v_lshlrev_b32 v142, 16, v231
    v_lshlrev_b32 v174, 16, v247
    v_and_b32 v143, s98, v231
    v_and_b32 v175, s98, v247
    v_lshlrev_b32 v144, 16, v232
    v_lshlrev_b32 v176, 16, v248
    v_and_b32 v145, s98, v232
    v_and_b32 v177, s98, v248
    v_lshlrev_b32 v146, 16, v233
    v_lshlrev_b32 v178, 16, v249
    v_and_b32 v147, s98, v233
    v_and_b32 v179, s98, v249
    v_lshlrev_b32 v148, 16, v234
    v_lshlrev_b32 v180, 16, v250
    v_and_b32 v149, s98, v234
    s_add_u32 m0, s28, 114688
    s_add_u32 s35, s21, 2048
    v_and_b32 v181, s98, v250
    buffer_load_dwordx4 v24, s[48:51], s35 offen offset:0 lds
    v_lshlrev_b32 v150, 16, v235
    v_lshlrev_b32 v182, 16, v251
    v_and_b32 v151, s98, v235
    v_and_b32 v183, s98, v251
    v_lshlrev_b32 v152, 16, v236
    v_lshlrev_b32 v184, 16, v252
    v_and_b32 v153, s98, v236
    v_and_b32 v185, s98, v252
    v_lshlrev_b32 v154, 16, v237
    v_lshlrev_b32 v186, 16, v253
    v_and_b32 v155, s98, v237
    v_and_b32 v187, s98, v253
    v_lshlrev_b32 v156, 16, v238
    v_lshlrev_b32 v188, 16, v254
    v_and_b32 v157, s98, v238
    v_and_b32 v189, s98, v254
    buffer_load_dwordx4 v25, s[48:51], s35 offen offset:1024 lds
    v_lshlrev_b32 v158, 16, v239
    v_lshlrev_b32 v190, 16, v255
    v_and_b32 v159, s98, v239
    v_and_b32 v191, s98, v255
    v_pk_add_f32 v[32:33], v[128:129], v[130:131]
    v_pk_add_f32 v[54:55], v[160:161], v[162:163]
    v_pk_add_f32 v[34:35], v[132:133], v[134:135]
    v_pk_add_f32 v[56:57], v[164:165], v[166:167]
    v_pk_add_f32 v[32:33], v[32:33], v[136:137]
    v_pk_add_f32 v[54:55], v[54:55], v[168:169]
    v_pk_add_f32 v[34:35], v[34:35], v[138:139]
    v_pk_add_f32 v[56:57], v[56:57], v[170:171]
    v_pk_add_f32 v[32:33], v[32:33], v[140:141]
    v_pk_add_f32 v[54:55], v[54:55], v[172:173]
    v_pk_add_f32 v[34:35], v[34:35], v[142:143]
    v_pk_add_f32 v[56:57], v[56:57], v[174:175]
    v_pk_add_f32 v[32:33], v[32:33], v[144:145]
    buffer_load_dwordx4 v26, s[48:51], s35 offen offset:2048 lds
    v_pk_add_f32 v[54:55], v[54:55], v[176:177]
    v_pk_add_f32 v[34:35], v[34:35], v[146:147]
    v_pk_add_f32 v[56:57], v[56:57], v[178:179]
    v_pk_add_f32 v[32:33], v[32:33], v[148:149]
    v_pk_add_f32 v[54:55], v[54:55], v[180:181]
    v_pk_add_f32 v[34:35], v[34:35], v[150:151]
    v_pk_add_f32 v[56:57], v[56:57], v[182:183]
    v_pk_add_f32 v[32:33], v[32:33], v[152:153]
    v_pk_add_f32 v[54:55], v[54:55], v[184:185]
    v_pk_add_f32 v[34:35], v[34:35], v[154:155]
    v_pk_add_f32 v[56:57], v[56:57], v[186:187]
    v_pk_add_f32 v[32:33], v[32:33], v[156:157]
    v_pk_add_f32 v[54:55], v[54:55], v[188:189]
    v_pk_add_f32 v[34:35], v[34:35], v[158:159]
    v_pk_add_f32 v[56:57], v[56:57], v[190:191]
    v_pk_add_f32 v[32:33], v[32:33], v[34:35]
    buffer_load_dwordx4 v27, s[48:51], s35 offen offset:3072 lds
    v_pk_add_f32 v[54:55], v[54:55], v[56:57]
    v_add_f32 v32, v32, v33
    v_add_f32 v54, v54, v55
    s_nop 0
    v_add_f32_dpp v32, v32, v32 row_ror:8 row_mask:0xf bank_mask:0xf
    v_add_f32_dpp v54, v54, v54 row_ror:8 row_mask:0xf bank_mask:0xf
    s_nop 0
    v_add_f32_dpp v32, v32, v32 row_ror:4 row_mask:0xf bank_mask:0xf
    v_add_f32_dpp v54, v54, v54 row_ror:4 row_mask:0xf bank_mask:0xf
    s_nop 0
    v_add_f32_dpp v32, v32, v32 row_ror:2 row_mask:0xf bank_mask:0xf
    v_add_f32_dpp v54, v54, v54 row_ror:2 row_mask:0xf bank_mask:0xf
    s_nop 0
    v_add_f32_dpp v32, v32, v32 row_ror:1 row_mask:0xf bank_mask:0xf
    v_add_f32_dpp v54, v54, v54 row_ror:1 row_mask:0xf bank_mask:0xf
    v_mul_f32 v32, 0xbb000000, v32
    v_mul_f32 v54, 0xbb000000, v54
    v_pk_add_f32 v[128:129], v[128:129], v[32:33] op_sel_hi:[1,0]
    v_pk_add_f32 v[160:161], v[160:161], v[54:55] op_sel_hi:[1,0]
    v_pk_add_f32 v[130:131], v[130:131], v[32:33] op_sel_hi:[1,0]
    s_add_u32 m0, s28, 131072
    v_pk_add_f32 v[162:163], v[162:163], v[54:55] op_sel_hi:[1,0]
    s_add_u32 s35, s21, 0
    buffer_load_dwordx4 v24, s[48:51], s35 offen offset:0 lds
    v_pk_add_f32 v[132:133], v[132:133], v[32:33] op_sel_hi:[1,0]
    v_pk_add_f32 v[164:165], v[164:165], v[54:55] op_sel_hi:[1,0]
    v_pk_add_f32 v[134:135], v[134:135], v[32:33] op_sel_hi:[1,0]
    v_pk_add_f32 v[166:167], v[166:167], v[54:55] op_sel_hi:[1,0]
    v_pk_add_f32 v[136:137], v[136:137], v[32:33] op_sel_hi:[1,0]
    v_pk_add_f32 v[168:169], v[168:169], v[54:55] op_sel_hi:[1,0]
    v_pk_add_f32 v[138:139], v[138:139], v[32:33] op_sel_hi:[1,0]
    v_pk_add_f32 v[170:171], v[170:171], v[54:55] op_sel_hi:[1,0]
    v_pk_add_f32 v[140:141], v[140:141], v[32:33] op_sel_hi:[1,0]
    v_pk_add_f32 v[172:173], v[172:173], v[54:55] op_sel_hi:[1,0]
    v_pk_add_f32 v[142:143], v[142:143], v[32:33] op_sel_hi:[1,0]
    v_pk_add_f32 v[174:175], v[174:175], v[54:55] op_sel_hi:[1,0]
    v_pk_add_f32 v[144:145], v[144:145], v[32:33] op_sel_hi:[1,0]
    v_pk_add_f32 v[176:177], v[176:177], v[54:55] op_sel_hi:[1,0]
    v_pk_add_f32 v[146:147], v[146:147], v[32:33] op_sel_hi:[1,0]
    v_pk_add_f32 v[178:179], v[178:179], v[54:55] op_sel_hi:[1,0]
    v_pk_add_f32 v[148:149], v[148:149], v[32:33] op_sel_hi:[1,0]
    buffer_load_dwordx4 v25, s[48:51], s35 offen offset:1024 lds
    v_pk_add_f32 v[180:181], v[180:181], v[54:55] op_sel_hi:[1,0]
    v_pk_add_f32 v[150:151], v[150:151], v[32:33] op_sel_hi:[1,0]
    v_pk_add_f32 v[182:183], v[182:183], v[54:55] op_sel_hi:[1,0]
    v_pk_add_f32 v[152:153], v[152:153], v[32:33] op_sel_hi:[1,0]
    v_pk_add_f32 v[184:185], v[184:185], v[54:55] op_sel_hi:[1,0]
    v_pk_add_f32 v[154:155], v[154:155], v[32:33] op_sel_hi:[1,0]
    v_pk_add_f32 v[186:187], v[186:187], v[54:55] op_sel_hi:[1,0]
    v_pk_add_f32 v[156:157], v[156:157], v[32:33] op_sel_hi:[1,0]
    v_pk_add_f32 v[188:189], v[188:189], v[54:55] op_sel_hi:[1,0]
    v_pk_add_f32 v[158:159], v[158:159], v[32:33] op_sel_hi:[1,0]
    v_pk_add_f32 v[190:191], v[190:191], v[54:55] op_sel_hi:[1,0]
    v_pk_mul_f32 v[34:35], v[128:129], v[128:129]
    v_pk_mul_f32 v[56:57], v[160:161], v[160:161]
    v_pk_mul_f32 v[36:37], v[130:131], v[130:131]
    v_pk_mul_f32 v[58:59], v[162:163], v[162:163]
    v_pk_fma_f32 v[34:35], v[132:133], v[132:133], v[34:35]
    buffer_load_dwordx4 v26, s[48:51], s35 offen offset:2048 lds
    v_pk_fma_f32 v[56:57], v[164:165], v[164:165], v[56:57]
    v_pk_fma_f32 v[36:37], v[134:135], v[134:135], v[36:37]
    v_pk_fma_f32 v[58:59], v[166:167], v[166:167], v[58:59]
    v_pk_fma_f32 v[34:35], v[136:137], v[136:137], v[34:35]
    v_pk_fma_f32 v[56:57], v[168:169], v[168:169], v[56:57]
    v_pk_fma_f32 v[36:37], v[138:139], v[138:139], v[36:37]
    v_pk_fma_f32 v[58:59], v[170:171], v[170:171], v[58:59]
    v_pk_fma_f32 v[34:35], v[140:141], v[140:141], v[34:35]
    v_pk_fma_f32 v[56:57], v[172:173], v[172:173], v[56:57]
    v_pk_fma_f32 v[36:37], v[142:143], v[142:143], v[36:37]
    v_pk_fma_f32 v[58:59], v[174:175], v[174:175], v[58:59]
    v_pk_fma_f32 v[34:35], v[144:145], v[144:145], v[34:35]
    v_pk_fma_f32 v[56:57], v[176:177], v[176:177], v[56:57]
    v_pk_fma_f32 v[36:37], v[146:147], v[146:147], v[36:37]
    v_pk_fma_f32 v[58:59], v[178:179], v[178:179], v[58:59]
    v_pk_fma_f32 v[34:35], v[148:149], v[148:149], v[34:35]
    buffer_load_dwordx4 v27, s[48:51], s35 offen offset:3072 lds
    v_pk_fma_f32 v[56:57], v[180:181], v[180:181], v[56:57]
    v_pk_fma_f32 v[36:37], v[150:151], v[150:151], v[36:37]
    v_pk_fma_f32 v[58:59], v[182:183], v[182:183], v[58:59]
    v_pk_fma_f32 v[34:35], v[152:153], v[152:153], v[34:35]
    v_pk_fma_f32 v[56:57], v[184:185], v[184:185], v[56:57]
    v_pk_fma_f32 v[36:37], v[154:155], v[154:155], v[36:37]
    v_pk_fma_f32 v[58:59], v[186:187], v[186:187], v[58:59]
    v_pk_fma_f32 v[34:35], v[156:157], v[156:157], v[34:35]
    v_pk_fma_f32 v[56:57], v[188:189], v[188:189], v[56:57]
    v_pk_fma_f32 v[36:37], v[158:159], v[158:159], v[36:37]
    v_pk_fma_f32 v[58:59], v[190:191], v[190:191], v[58:59]
    v_pk_add_f32 v[34:35], v[34:35], v[36:37]
    v_pk_add_f32 v[56:57], v[56:57], v[58:59]
    v_add_f32 v34, v34, v35
    v_add_f32 v56, v56, v57
    s_nop 0
    v_add_f32_dpp v34, v34, v34 row_ror:8 row_mask:0xf bank_mask:0xf
    v_lshlrev_b32 v11, 4, v0
    v_add_f32_dpp v56, v56, v56 row_ror:8 row_mask:0xf bank_mask:0xf
    s_mov_b32 s43, 65536
    v_add_f32_dpp v34, v34, v34 row_ror:4 row_mask:0xf bank_mask:0xf
    buffer_load_dwordx4 v[40:43], v11, s[84:87], s43 offen sc1
    v_add_f32_dpp v56, v56, v56 row_ror:4 row_mask:0xf bank_mask:0xf
    v_add_f32_dpp v34, v34, v34 row_ror:2 row_mask:0xf bank_mask:0xf
    s_nop 0
    v_add_f32_dpp v56, v56, v56 row_ror:2 row_mask:0xf bank_mask:0xf
    v_add_f32_dpp v34, v34, v34 row_ror:1 row_mask:0xf bank_mask:0xf
    s_nop 0
    v_add_f32_dpp v56, v56, v56 row_ror:1 row_mask:0xf bank_mask:0xf
    v_mov_b32 v35, 0x3727c5ac
    v_mov_b32 v57, 0x3727c5ac
    v_fmac_f32 v35, 0x3b000000, v34
    v_fmac_f32 v57, 0x3b000000, v56
    v_rsq_f32 v34, v35
    v_rsq_f32 v56, v57
    v_pk_mul_f32 v[128:129], v[128:129], v[34:35] op_sel_hi:[1,0]
    v_pk_mul_f32 v[160:161], v[160:161], v[56:57] op_sel_hi:[1,0]
    v_pk_mul_f32 v[130:131], v[130:131], v[34:35] op_sel_hi:[1,0]
    v_pk_mul_f32 v[162:163], v[162:163], v[56:57] op_sel_hi:[1,0]
    v_pk_mul_f32 v[132:133], v[132:133], v[34:35] op_sel_hi:[1,0]
    v_pk_mul_f32 v[164:165], v[164:165], v[56:57] op_sel_hi:[1,0]
    v_pk_mul_f32 v[134:135], v[134:135], v[34:35] op_sel_hi:[1,0]
    v_pk_mul_f32 v[166:167], v[166:167], v[56:57] op_sel_hi:[1,0]
    v_pk_mul_f32 v[136:137], v[136:137], v[34:35] op_sel_hi:[1,0]
    v_pk_mul_f32 v[168:169], v[168:169], v[56:57] op_sel_hi:[1,0]
    v_pk_mul_f32 v[138:139], v[138:139], v[34:35] op_sel_hi:[1,0]
    v_pk_mul_f32 v[170:171], v[170:171], v[56:57] op_sel_hi:[1,0]
    v_pk_mul_f32 v[140:141], v[140:141], v[34:35] op_sel_hi:[1,0]
    v_pk_mul_f32 v[172:173], v[172:173], v[56:57] op_sel_hi:[1,0]
    v_pk_mul_f32 v[142:143], v[142:143], v[34:35] op_sel_hi:[1,0]
    v_pk_mul_f32 v[174:175], v[174:175], v[56:57] op_sel_hi:[1,0]
    v_pk_mul_f32 v[144:145], v[144:145], v[34:35] op_sel_hi:[1,0]
    v_pk_mul_f32 v[176:177], v[176:177], v[56:57] op_sel_hi:[1,0]
    v_pk_mul_f32 v[146:147], v[146:147], v[34:35] op_sel_hi:[1,0]
    v_pk_mul_f32 v[178:179], v[178:179], v[56:57] op_sel_hi:[1,0]
    v_pk_mul_f32 v[148:149], v[148:149], v[34:35] op_sel_hi:[1,0]
    v_pk_mul_f32 v[180:181], v[180:181], v[56:57] op_sel_hi:[1,0]
    v_pk_mul_f32 v[150:151], v[150:151], v[34:35] op_sel_hi:[1,0]
    v_pk_mul_f32 v[182:183], v[182:183], v[56:57] op_sel_hi:[1,0]
    v_pk_mul_f32 v[152:153], v[152:153], v[34:35] op_sel_hi:[1,0]
    v_pk_mul_f32 v[184:185], v[184:185], v[56:57] op_sel_hi:[1,0]
    v_pk_mul_f32 v[154:155], v[154:155], v[34:35] op_sel_hi:[1,0]
    v_pk_mul_f32 v[186:187], v[186:187], v[56:57] op_sel_hi:[1,0]
    v_pk_mul_f32 v[156:157], v[156:157], v[34:35] op_sel_hi:[1,0]
    v_pk_mul_f32 v[188:189], v[188:189], v[56:57] op_sel_hi:[1,0]
    v_pk_mul_f32 v[158:159], v[158:159], v[34:35] op_sel_hi:[1,0]
    v_pk_mul_f32 v[190:191], v[190:191], v[56:57] op_sel_hi:[1,0]
    s_waitcnt vmcnt(13)
    s_barrier
    ds_read_b64_tr_b16 a[0:1], v28 offset:0
    s_add_u32 m0, s28, 49152
    s_add_u32 s35, s22, 1024
    buffer_load_dwordx4 v24, s[48:51], s35 offen offset:0 lds
    ds_read_b64_tr_b16 a[2:3], v28 offset:512
    ds_read_b64_tr_b16 a[64:65], v28 offset:16384
    buffer_load_dwordx4 v25, s[48:51], s35 offen offset:1024 lds
    ds_read_b64_tr_b16 a[66:67], v28 offset:16896
    ds_read_b64_tr_b16 a[128:129], v28 offset:32768
    buffer_load_dwordx4 v26, s[48:51], s35 offen offset:2048 lds
    ds_read_b64_tr_b16 a[130:131], v28 offset:33280
    buffer_load_dwordx4 v27, s[48:51], s35 offen offset:3072 lds
    ds_read_b64_tr_b16 a[4:5], v28 offset:4096
    ds_read_b64_tr_b16 a[6:7], v28 offset:4608
    s_add_u32 m0, s28, 65536
    s_add_u32 s35, s22, 2048
    ds_read_b64_tr_b16 a[68:69], v28 offset:20480
    buffer_load_dwordx4 v24, s[48:51], s35 offen offset:0 lds
    ds_read_b64_tr_b16 a[70:71], v28 offset:20992
    buffer_load_dwordx4 v25, s[48:51], s35 offen offset:1024 lds
    ds_read_b64_tr_b16 a[132:133], v28 offset:36864
    ds_read_b64_tr_b16 a[134:135], v28 offset:37376
    buffer_load_dwordx4 v26, s[48:51], s35 offen offset:2048 lds
    ds_read_b64_tr_b16 a[8:9], v28 offset:8192
    ds_read_b64_tr_b16 a[10:11], v28 offset:8704
    buffer_load_dwordx4 v27, s[48:51], s35 offen offset:3072 lds
    ds_read_b64_tr_b16 a[72:73], v28 offset:24576
    ds_read_b64_tr_b16 a[74:75], v28 offset:25088
    s_add_u32 m0, s28, 81920
    s_add_u32 s35, s22, 0
    buffer_load_dwordx4 v24, s[48:51], s35 offen offset:0 lds
    ds_read_b64_tr_b16 a[136:137], v28 offset:40960
    ds_read_b64_tr_b16 a[138:139], v28 offset:41472
    buffer_load_dwordx4 v25, s[48:51], s35 offen offset:1024 lds
    ds_read_b64_tr_b16 a[12:13], v28 offset:12288
    ds_read_b64_tr_b16 a[14:15], v28 offset:12800
    buffer_load_dwordx4 v26, s[48:51], s35 offen offset:2048 lds
    ds_read_b64_tr_b16 a[76:77], v28 offset:28672
    ds_read_b64_tr_b16 a[78:79], v28 offset:29184
    buffer_load_dwordx4 v27, s[48:51], s35 offen offset:3072 lds
    ds_read_b64_tr_b16 a[140:141], v28 offset:45056
    ds_read_b64_tr_b16 a[142:143], v28 offset:45568
    s_lshl_b32 s42, s6, 14
    s_add_u32 s42, s42, s28
    v_and_b32 v21, 31, v1
    v_lshlrev_b32 v21, 7, v21
    buffer_load_dword a255, v21, s[56:59], s42 offen
    s_waitcnt vmcnt(13)
    v_perm_b32 v9, v41, v40, s3
    v_xor_b32 v8, v9, v4
    v_perm_b32 v9, v43, v42, s3
    v_bitop3_b32 v8, v8, v9, v4 bitop3:0xf6
    v_cmp_ne_u32 vcc, 0, v8
    s_cbranch_vccz Ldone_2
    s_mov_b32 s15, 0
    s_nop 3
Lspin_1:
    s_mov_b32 s43, 65536
    buffer_load_dwordx4 v[40:43], v11, s[84:87], s43 offen sc1
    s_waitcnt vmcnt(0)
    v_perm_b32 v9, v41, v40, s3
    v_xor_b32 v8, v9, v4
    v_perm_b32 v9, v43, v42, s3
    v_bitop3_b32 v8, v8, v9, v4 bitop3:0xf6
    v_cmp_ne_u32 vcc, 0, v8
    s_cbranch_vccz Ldone_2
    s_add_u32 s15, s15, 1
    s_cmp_lt_u32 s15, 400000
    s_cbranch_scc1 Lspin_1
Ldone_2:
    s_nop 1
    v_lshrrev_b32 v6, 5, v0
    v_lshlrev_b32 v6, 9, v6
    v_and_b32 v8, 1, v0
    v_lshl_add_u32 v6, v8, 8, v6
    v_bfe_u32 v8, v0, 1, 4
    v_lshl_add_u32 v6, v8, 4, v6
    v_add_u32 v6, 147456, v6
    v_and_b32 v40, s98, v40
    v_and_b32 v41, s98, v41
    v_and_b32 v42, s98, v42
    v_and_b32 v43, s98, v43
    ds_write_b128 v6, v[40:43] offset:0
    s_waitcnt lgkmcnt(0)
    s_barrier
    v_add_u32 v6, s24, v20
    ds_read_b128 v[192:195], v6 offset:2048
    ds_read_b128 v[196:199], v6 offset:2304
    ds_read_b128 v[200:203], v6
    ds_read_b128 v[204:207], v6 offset:256
    v_add_u32 v6, s25, v20
    ds_read_b128 v[208:211], v6 offset:2048
    ds_read_b128 v[212:215], v6 offset:2304
    ds_read_b128 v[216:219], v6
    ds_read_b128 v[220:223], v6 offset:256
    v_add_u32 v6, s26, v20
    ds_read_b128 v[224:227], v6 offset:2048
    ds_read_b128 v[228:231], v6 offset:2304
    ds_read_b128 v[232:235], v6
    ds_read_b128 v[236:239], v6 offset:256
    v_add_u32 v6, s27, v20
    ds_read_b128 v[240:243], v6 offset:2048
    ds_read_b128 v[244:247], v6 offset:2304
    ds_read_b128 v[248:251], v6
    ds_read_b64_tr_b16 a[16:17], v30 offset:0
    ds_read_b128 v[252:255], v6 offset:256
    ds_read_b64_tr_b16 a[18:19], v30 offset:512
    ds_read_b64_tr_b16 a[80:81], v30 offset:16384
    ds_read_b64_tr_b16 a[82:83], v30 offset:16896
    ds_read_b64_tr_b16 a[144:145], v30 offset:32768
    ds_read_b64_tr_b16 a[146:147], v30 offset:33280
    ds_read_b64_tr_b16 a[20:21], v30 offset:4096
    ds_read_b64_tr_b16 a[22:23], v30 offset:4608
    s_waitcnt lgkmcnt(15)
    ds_read_b64_tr_b16 a[84:85], v30 offset:20480
    v_pk_fma_f32 v[64:65], v[64:65], v[192:193], v[200:201]
    v_pk_fma_f32 v[66:67], v[66:67], v[194:195], v[202:203]
    v_pk_fma_f32 v[68:69], v[68:69], v[196:197], v[204:205]
    ds_read_b64_tr_b16 a[86:87], v30 offset:20992
    v_pk_fma_f32 v[70:71], v[70:71], v[198:199], v[206:207]
    v_cvt_pk_bf16_f32 v64, v64, v65
    v_cvt_pk_bf16_f32 v65, v66, v67
    ds_read_b64_tr_b16 a[148:149], v30 offset:36864
    v_cvt_pk_bf16_f32 v66, v68, v69
    v_cvt_pk_bf16_f32 v67, v70, v71
    ds_write_b128 v16, v[64:67] offset:0
    ds_read_b64_tr_b16 a[150:151], v30 offset:37376
    v_pk_fma_f32 v[96:97], v[96:97], v[192:193], v[200:201]
    v_pk_fma_f32 v[98:99], v[98:99], v[194:195], v[202:203]
    v_pk_fma_f32 v[100:101], v[100:101], v[196:197], v[204:205]
    ds_read_b64_tr_b16 a[24:25], v30 offset:8192
    v_pk_fma_f32 v[102:103], v[102:103], v[198:199], v[206:207]
    v_cvt_pk_bf16_f32 v96, v96, v97
    v_cvt_pk_bf16_f32 v97, v98, v99
    ds_read_b64_tr_b16 a[26:27], v30 offset:8704
    v_cvt_pk_bf16_f32 v98, v100, v101
    v_cvt_pk_bf16_f32 v99, v102, v103
    ds_write_b128 v17, v[96:99] offset:0
    v_pk_fma_f32 v[128:129], v[128:129], v[192:193], v[200:201]
    ds_read_b64_tr_b16 a[88:89], v30 offset:24576
    v_pk_fma_f32 v[130:131], v[130:131], v[194:195], v[202:203]
    v_pk_fma_f32 v[132:133], v[132:133], v[196:197], v[204:205]
    v_pk_fma_f32 v[134:135], v[134:135], v[198:199], v[206:207]
    ds_read_b64_tr_b16 a[90:91], v30 offset:25088
    v_cvt_pk_bf16_f32 v128, v128, v129
    v_cvt_pk_bf16_f32 v129, v130, v131
    v_cvt_pk_bf16_f32 v130, v132, v133
    ds_read_b64_tr_b16 a[152:153], v30 offset:40960
    v_cvt_pk_bf16_f32 v131, v134, v135
    ds_write_b128 v18, v[128:131] offset:0
    v_pk_fma_f32 v[160:161], v[160:161], v[192:193], v[200:201]
    ds_read_b64_tr_b16 a[154:155], v30 offset:41472
    v_pk_fma_f32 v[162:163], v[162:163], v[194:195], v[202:203]
    v_pk_fma_f32 v[164:165], v[164:165], v[196:197], v[204:205]
    v_pk_fma_f32 v[166:167], v[166:167], v[198:199], v[206:207]
    ds_read_b64_tr_b16 a[28:29], v30 offset:12288
    v_cvt_pk_bf16_f32 v160, v160, v161
    v_cvt_pk_bf16_f32 v161, v162, v163
    v_cvt_pk_bf16_f32 v162, v164, v165
    ds_read_b64_tr_b16 a[30:31], v30 offset:12800
    v_cvt_pk_bf16_f32 v163, v166, v167
    ds_write_b128 v19, v[160:163] offset:0
    s_waitcnt lgkmcnt(15)
    ds_read_b64_tr_b16 a[92:93], v30 offset:28672
    v_pk_fma_f32 v[72:73], v[72:73], v[208:209], v[216:217]
    v_pk_fma_f32 v[74:75], v[74:75], v[210:211], v[218:219]
    v_pk_fma_f32 v[76:77], v[76:77], v[212:213], v[220:221]
    ds_read_b64_tr_b16 a[94:95], v30 offset:29184
    v_pk_fma_f32 v[78:79], v[78:79], v[214:215], v[222:223]
    v_cvt_pk_bf16_f32 v72, v72, v73
    v_cvt_pk_bf16_f32 v73, v74, v75
    ds_read_b64_tr_b16 a[156:157], v30 offset:45056
    v_cvt_pk_bf16_f32 v74, v76, v77
    v_cvt_pk_bf16_f32 v75, v78, v79
    ds_write_b128 v16, v[72:75] offset:16384
    ds_read_b64_tr_b16 a[158:159], v30 offset:45568
    v_pk_fma_f32 v[104:105], v[104:105], v[208:209], v[216:217]
    v_pk_fma_f32 v[106:107], v[106:107], v[210:211], v[218:219]
    v_pk_fma_f32 v[108:109], v[108:109], v[212:213], v[220:221]
    v_pk_fma_f32 v[110:111], v[110:111], v[214:215], v[222:223]
    v_cvt_pk_bf16_f32 v104, v104, v105
    v_cvt_pk_bf16_f32 v105, v106, v107
    v_cvt_pk_bf16_f32 v106, v108, v109
    v_cvt_pk_bf16_f32 v107, v110, v111
    ds_write_b128 v17, v[104:107] offset:16384
    v_pk_fma_f32 v[136:137], v[136:137], v[208:209], v[216:217]
    v_pk_fma_f32 v[138:139], v[138:139], v[210:211], v[218:219]
    v_pk_fma_f32 v[140:141], v[140:141], v[212:213], v[220:221]
    v_pk_fma_f32 v[142:143], v[142:143], v[214:215], v[222:223]
    v_cvt_pk_bf16_f32 v136, v136, v137
    v_cvt_pk_bf16_f32 v137, v138, v139
    v_cvt_pk_bf16_f32 v138, v140, v141
    v_cvt_pk_bf16_f32 v139, v142, v143
    ds_write_b128 v18, v[136:139] offset:16384
    v_pk_fma_f32 v[168:169], v[168:169], v[208:209], v[216:217]
    v_pk_fma_f32 v[170:171], v[170:171], v[210:211], v[218:219]
    v_pk_fma_f32 v[172:173], v[172:173], v[212:213], v[220:221]
    v_pk_fma_f32 v[174:175], v[174:175], v[214:215], v[222:223]
    v_cvt_pk_bf16_f32 v168, v168, v169
    v_cvt_pk_bf16_f32 v169, v170, v171
    v_cvt_pk_bf16_f32 v170, v172, v173
    v_cvt_pk_bf16_f32 v171, v174, v175
    ds_write_b128 v19, v[168:171] offset:16384
    s_waitcnt lgkmcnt(15)
    v_pk_fma_f32 v[80:81], v[80:81], v[224:225], v[232:233]
    v_pk_fma_f32 v[82:83], v[82:83], v[226:227], v[234:235]
    v_pk_fma_f32 v[84:85], v[84:85], v[228:229], v[236:237]
    v_pk_fma_f32 v[86:87], v[86:87], v[230:231], v[238:239]
    v_cvt_pk_bf16_f32 v80, v80, v81
    v_cvt_pk_bf16_f32 v81, v82, v83
    v_cvt_pk_bf16_f32 v82, v84, v85
    v_cvt_pk_bf16_f32 v83, v86, v87
    ds_write_b128 v16, v[80:83] offset:32768
    v_pk_fma_f32 v[112:113], v[112:113], v[224:225], v[232:233]
    v_pk_fma_f32 v[114:115], v[114:115], v[226:227], v[234:235]
    v_pk_fma_f32 v[116:117], v[116:117], v[228:229], v[236:237]
    v_pk_fma_f32 v[118:119], v[118:119], v[230:231], v[238:239]
    v_cvt_pk_bf16_f32 v112, v112, v113
    v_cvt_pk_bf16_f32 v113, v114, v115
    v_cvt_pk_bf16_f32 v114, v116, v117
    v_cvt_pk_bf16_f32 v115, v118, v119
    ds_write_b128 v17, v[112:115] offset:32768
    v_pk_fma_f32 v[144:145], v[144:145], v[224:225], v[232:233]
    v_pk_fma_f32 v[146:147], v[146:147], v[226:227], v[234:235]
    v_pk_fma_f32 v[148:149], v[148:149], v[228:229], v[236:237]
    v_pk_fma_f32 v[150:151], v[150:151], v[230:231], v[238:239]
    v_cvt_pk_bf16_f32 v144, v144, v145
    v_cvt_pk_bf16_f32 v145, v146, v147
    v_cvt_pk_bf16_f32 v146, v148, v149
    v_cvt_pk_bf16_f32 v147, v150, v151
    ds_write_b128 v18, v[144:147] offset:32768
    v_pk_fma_f32 v[176:177], v[176:177], v[224:225], v[232:233]
    v_pk_fma_f32 v[178:179], v[178:179], v[226:227], v[234:235]
    v_pk_fma_f32 v[180:181], v[180:181], v[228:229], v[236:237]
    v_pk_fma_f32 v[182:183], v[182:183], v[230:231], v[238:239]
    v_cvt_pk_bf16_f32 v176, v176, v177
    v_cvt_pk_bf16_f32 v177, v178, v179
    v_cvt_pk_bf16_f32 v178, v180, v181
    v_cvt_pk_bf16_f32 v179, v182, v183
    ds_write_b128 v19, v[176:179] offset:32768
    v_bfe_u32 v6, v1, 2, 1
    v_mul_u32_u24 v6, 0x8000, v6
    v_lshl_or_b32 v6, v6, 16, v6
    v_lshl_or_b32 v44, v45, 16, v44
    v_lshl_or_b32 v45, v47, 16, v46
    v_lshl_or_b32 v46, v49, 16, v48
    v_lshl_or_b32 v47, v51, 16, v50
    v_xor_b32 v136, v6, v44
    v_xor_b32 v137, v6, v45
    v_xor_b32 v138, v6, v46
    v_xor_b32 v139, v6, v47
    s_waitcnt lgkmcnt(0)
    s_barrier
    ds_read_b128 v[32:35], v12 offset:0
    ds_read_b128 v[36:39], v12 offset:4096
    ds_read_b128 v[40:43], v12 offset:8192
    ds_read_b128 v[44:47], v12 offset:12288
    ds_read_b128 v[48:51], v13 offset:0
    ds_read_b128 v[52:55], v13 offset:4096
    ds_read_b128 v[56:59], v13 offset:8192
    ds_read_b128 v[60:63], v13 offset:12288
    ds_read_b128 v[64:67], v14 offset:0
    s_waitcnt lgkmcnt(5)
    v_mfma_f32_16x16x32_bf16 v[192:195], a[0:3], v[32:35], 0
    s_add_u32 m0, s28, 98304
    s_add_u32 s35, s23, 1024
    v_mfma_f32_16x16x32_bf16 v[208:211], v[32:35], a[64:67], 0
    buffer_load_dwordx4 v24, s[48:51], s35 offen offset:0 lds
    v_accvgpr_read_b32 v8, a248
    v_mfma_f32_16x16x32_bf16 v[224:227], a[128:131], v[32:35], 0
    buffer_load_dwordx4 v25, s[48:51], s35 offen offset:1024 lds
    ds_read_b128 v[68:71], v14 offset:4096
    v_mfma_f32_16x16x32_bf16 v[196:199], a[0:3], v[36:39], 0
    v_accvgpr_read_b32 v9, a249
    v_mfma_f32_16x16x32_bf16 v[212:215], v[36:39], a[64:67], 0
    v_mfma_f32_16x16x32_bf16 v[228:231], a[128:131], v[36:39], 0
    buffer_load_dwordx4 v26, s[48:51], s35 offen offset:2048 lds
    ds_read_b128 v[72:75], v14 offset:8192
    v_mfma_f32_16x16x32_bf16 v[200:203], a[0:3], v[40:43], 0
    v_accvgpr_read_b32 v129, a250
    v_mfma_f32_16x16x32_bf16 v[216:219], v[40:43], a[64:67], 0
    v_mfma_f32_16x16x32_bf16 v[232:235], a[128:131], v[40:43], 0
    buffer_load_dwordx4 v27, s[48:51], s35 offen offset:3072 lds
    ds_read_b128 v[76:79], v14 offset:12288
    v_mfma_f32_16x16x32_bf16 v[204:207], a[0:3], v[44:47], 0
    v_accvgpr_read_b32 v130, a251
    v_mfma_f32_16x16x32_bf16 v[220:223], v[44:47], a[64:67], 0
    v_mfma_f32_16x16x32_bf16 v[236:239], a[128:131], v[44:47], 0
    ds_read_b128 v[32:35], v15 offset:0
    s_waitcnt lgkmcnt(5)
    v_mfma_f32_16x16x32_bf16 v[192:195], a[4:7], v[48:51], v[192:195]
    s_add_u32 m0, s28, 114688
    s_add_u32 s35, s23, 2048
    v_mfma_f32_16x16x32_bf16 v[208:211], v[48:51], a[68:71], v[208:211]
    buffer_load_dwordx4 v24, s[48:51], s35 offen offset:0 lds
    buffer_load_dwordx4 v25, s[48:51], s35 offen offset:1024 lds
    v_mfma_f32_16x16x32_bf16 v[224:227], a[132:135], v[48:51], v[224:227]
    v_xor_b32 v143, 16, v8
    ds_read_b128 v[36:39], v15 offset:4096
    v_mfma_f32_16x16x32_bf16 v[196:199], a[4:7], v[52:55], v[196:199]
    v_mfma_f32_16x16x32_bf16 v[212:215], v[52:55], a[68:71], v[212:215]
    buffer_load_dwordx4 v26, s[48:51], s35 offen offset:2048 lds
    v_xor_b32 v10, 32, v9
    v_mfma_f32_16x16x32_bf16 v[228:231], a[132:135], v[52:55], v[228:231]
    ds_read_b128 v[40:43], v15 offset:8192
    v_mfma_f32_16x16x32_bf16 v[200:203], a[4:7], v[56:59], v[200:203]
    v_mfma_f32_16x16x32_bf16 v[216:219], v[56:59], a[68:71], v[216:219]
    buffer_load_dwordx4 v27, s[48:51], s35 offen offset:3072 lds
    v_mov_b32 v168, 0x3f803f80
    v_mfma_f32_16x16x32_bf16 v[232:235], a[132:135], v[56:59], v[232:235]
    ds_read_b128 v[44:47], v15 offset:12288
    v_mfma_f32_16x16x32_bf16 v[204:207], a[4:7], v[60:63], v[204:207]
    v_mfma_f32_16x16x32_bf16 v[220:223], v[60:63], a[68:71], v[220:223]
    s_add_u32 m0, s28, 131072
    s_add_u32 s35, s23, 0
    v_mfma_f32_16x16x32_bf16 v[236:239], a[132:135], v[60:63], v[236:239]
    ds_read_b128 v[48:51], v12 offset:16384
    s_waitcnt lgkmcnt(5)
    v_mfma_f32_16x16x32_bf16 v[192:195], a[8:11], v[64:67], v[192:195]
    buffer_load_dwordx4 v24, s[48:51], s35 offen offset:0 lds
    buffer_load_dwordx4 v25, s[48:51], s35 offen offset:1024 lds
    v_mfma_f32_16x16x32_bf16 v[208:211], v[64:67], a[72:75], v[208:211]
    v_mov_b32 v169, 0x3f803f80
    v_mfma_f32_16x16x32_bf16 v[224:227], a[136:139], v[64:67], v[224:227]
    v_mov_b32 v170, 0x3f803f80
    ds_read_b128 v[52:55], v12 offset:20480
    v_mfma_f32_16x16x32_bf16 v[196:199], a[8:11], v[68:71], v[196:199]
    buffer_load_dwordx4 v26, s[48:51], s35 offen offset:2048 lds
    v_mfma_f32_16x16x32_bf16 v[212:215], v[68:71], a[72:75], v[212:215]
    v_mfma_f32_16x16x32_bf16 v[228:231], a[136:139], v[68:71], v[228:231]
    v_mov_b32 v171, 0x3f803f80
    ds_read_b128 v[56:59], v12 offset:24576
    v_mfma_f32_16x16x32_bf16 v[200:203], a[8:11], v[72:75], v[200:203]
    buffer_load_dwordx4 v27, s[48:51], s35 offen offset:3072 lds
    v_mfma_f32_16x16x32_bf16 v[216:219], v[72:75], a[72:75], v[216:219]
    v_mfma_f32_16x16x32_bf16 v[232:235], a[136:139], v[72:75], v[232:235]
    ds_read_b128 v[60:63], v12 offset:28672
    v_mfma_f32_16x16x32_bf16 v[204:207], a[8:11], v[76:79], v[204:207]
    s_cmp_ge_u32 s5, 2
    s_cselect_b32 s72, s64, s60
    s_cselect_b32 s73, s65, s61
    v_mfma_f32_16x16x32_bf16 v[220:223], v[76:79], a[72:75], v[220:223]
    s_mov_b32 s74, 1409024
    s_mov_b32 s75, 0x20000
    v_mfma_f32_16x16x32_bf16 v[236:239], a[136:139], v[76:79], v[236:239]
    ds_read_b128 v[64:67], v13 offset:16384
    s_waitcnt lgkmcnt(5)
    v_mfma_f32_16x16x32_bf16 v[192:195], a[12:15], v[32:35], v[192:195]
    s_lshl_b32 s42, s6, 1
    s_and_b32 s43, s5, 1
    v_mfma_f32_16x16x32_bf16 v[208:211], v[32:35], a[76:79], v[208:211]
    s_add_u32 s42, s42, s43
    s_mul_i32 s42, s42, 22016
    v_mfma_f32_16x16x32_bf16 v[224:227], a[140:143], v[32:35], v[224:227]
    s_and_b32 s43, s2, 3
    ds_read_b128 v[68:71], v13 offset:20480
    v_mfma_f32_16x16x32_bf16 v[196:199], a[12:15], v[36:39], v[196:199]
    s_mul_i32 s43, s43, 699072
    s_lshr_b32 s43, s43, 16
    v_mfma_f32_16x16x32_bf16 v[212:215], v[36:39], a[76:79], v[212:215]
    s_lshl_b32 s43, s43, 6
    s_add_u32 s42, s42, s43
    v_mfma_f32_16x16x32_bf16 v[228:231], a[140:143], v[36:39], v[228:231]
    v_lshrrev_b32 v21, 3, v1
    ds_read_b128 v[72:75], v13 offset:24576
    v_mfma_f32_16x16x32_bf16 v[200:203], a[12:15], v[40:43], v[200:203]
    v_mul_u32_u24 v21, 2752, v21
    v_and_b32 v22, 7, v1
    v_mfma_f32_16x16x32_bf16 v[216:219], v[40:43], a[76:79], v[216:219]
    v_mul_u32_u24 v22, 100, v22
    v_add_u32 v21, v21, v22
    v_mfma_f32_16x16x32_bf16 v[232:235], a[140:143], v[40:43], v[232:235]
    buffer_load_dword a255, v21, s[72:75], s42 offen
    ds_read_b128 v[76:79], v13 offset:28672
    v_mfma_f32_16x16x32_bf16 v[204:207], a[12:15], v[44:47], v[204:207]
    s_mul_i32 s13, s2, 5504
    s_mul_i32 s14, s5, 1408
    v_mfma_f32_16x16x32_bf16 v[220:223], v[44:47], a[76:79], v[220:223]
    s_add_u32 s13, s13, s14
    v_min_u32 v21, 10, v1
    v_mfma_f32_16x16x32_bf16 v[236:239], a[140:143], v[44:47], v[236:239]
    v_lshlrev_b32 v21, 7, v21
    buffer_load_dword a255, v21, s[68:71], s13 offen
    s_waitcnt vmcnt(15)
    s_barrier
    ds_read_b128 v[32:35], v14 offset:16384
    s_waitcnt lgkmcnt(5)
    v_mfma_f32_16x16x32_bf16 v[192:195], a[16:19], v[48:51], v[192:195]
    ds_read_b64_tr_b16 a[32:33], v29 offset:0
    ds_read_b64_tr_b16 a[34:35], v29 offset:512
    v_mfma_f32_16x16x32_bf16 v[208:211], v[48:51], a[80:83], v[208:211]
    ds_read_b64_tr_b16 a[96:97], v29 offset:16384
    v_accvgpr_read_b32 v24, a243
    v_mfma_f32_16x16x32_bf16 v[224:227], a[144:147], v[48:51], v[224:227]
    ds_read_b64_tr_b16 a[98:99], v29 offset:16896
    ds_read_b128 v[36:39], v14 offset:20480
    v_mfma_f32_16x16x32_bf16 v[196:199], a[16:19], v[52:55], v[196:199]
    ds_read_b64_tr_b16 a[160:161], v29 offset:32768
    ds_read_b64_tr_b16 a[162:163], v29 offset:33280
    v_mfma_f32_16x16x32_bf16 v[212:215], v[52:55], a[80:83], v[212:215]
    ds_read_b64_tr_b16 a[36:37], v29 offset:4096
    v_accvgpr_read_b32 v25, a244
    v_mfma_f32_16x16x32_bf16 v[228:231], a[144:147], v[52:55], v[228:231]
    ds_read_b64_tr_b16 a[38:39], v29 offset:4608
    ds_read_b128 v[40:43], v14 offset:24576
    v_mfma_f32_16x16x32_bf16 v[200:203], a[16:19], v[56:59], v[200:203]
    ds_read_b64_tr_b16 a[100:101], v29 offset:20480
    v_accvgpr_read_b32 v26, a245
    v_mfma_f32_16x16x32_bf16 v[216:219], v[56:59], a[80:83], v[216:219]
    ds_read_b64_tr_b16 a[102:103], v29 offset:20992
    ds_read_b64_tr_b16 a[164:165], v29 offset:36864
    v_mfma_f32_16x16x32_bf16 v[232:235], a[144:147], v[56:59], v[232:235]
    ds_read_b64_tr_b16 a[166:167], v29 offset:37376
    ds_read_b128 v[44:47], v14 offset:28672
    v_mfma_f32_16x16x32_bf16 v[204:207], a[16:19], v[60:63], v[204:207]
    ds_read_b64_tr_b16 a[40:41], v29 offset:8192
    v_accvgpr_read_b32 v27, a246
    v_mfma_f32_16x16x32_bf16 v[220:223], v[60:63], a[80:83], v[220:223]
    ds_read_b64_tr_b16 a[42:43], v29 offset:8704
    v_mfma_f32_16x16x32_bf16 v[236:239], a[144:147], v[60:63], v[236:239]
    ds_read_b128 v[48:51], v15 offset:16384
    s_waitcnt lgkmcnt(15)
    v_mfma_f32_16x16x32_bf16 v[192:195], a[20:23], v[64:67], v[192:195]
    ds_read_b64_tr_b16 a[104:105], v29 offset:24576
    ds_read_b64_tr_b16 a[106:107], v29 offset:25088
    v_mfma_f32_16x16x32_bf16 v[208:211], v[64:67], a[84:87], v[208:211]
    ds_read_b64_tr_b16 a[168:169], v29 offset:40960
    ds_read_b64_tr_b16 a[170:171], v29 offset:41472
    v_mfma_f32_16x16x32_bf16 v[224:227], a[148:151], v[64:67], v[224:227]
    ds_read_b64_tr_b16 a[44:45], v29 offset:12288
    ds_read_b128 v[52:55], v15 offset:20480
    v_mfma_f32_16x16x32_bf16 v[196:199], a[20:23], v[68:71], v[196:199]
    ds_read_b64_tr_b16 a[46:47], v29 offset:12800
    ds_read_b64_tr_b16 a[108:109], v29 offset:28672
    v_mfma_f32_16x16x32_bf16 v[212:215], v[68:71], a[84:87], v[212:215]
    ds_read_b64_tr_b16 a[110:111], v29 offset:29184
    s_lshl_b32 s42, s5, 17
    v_mfma_f32_16x16x32_bf16 v[228:231], a[148:151], v[68:71], v[228:231]
    ds_read_b64_tr_b16 a[172:173], v29 offset:45056
    ds_read_b128 v[56:59], v15 offset:24576
    v_mfma_f32_16x16x32_bf16 v[200:203], a[20:23], v[72:75], v[200:203]
    ds_read_b64_tr_b16 a[174:175], v29 offset:45568
    s_lshl_b32 s43, s9, 7
    v_mfma_f32_16x16x32_bf16 v[216:219], v[72:75], a[84:87], v[216:219]
    s_add_u32 s42, s42, s43
    v_mfma_f32_16x16x32_bf16 v[232:235], a[148:151], v[72:75], v[232:235]
    ds_read_b128 v[60:63], v15 offset:28672
    v_mfma_f32_16x16x32_bf16 v[204:207], a[20:23], v[76:79], v[204:207]
    s_lshl_b32 s43, s5, 14
    v_mfma_f32_16x16x32_bf16 v[220:223], v[76:79], a[84:87], v[220:223]
    v_mfma_f32_16x16x32_bf16 v[236:239], a[148:151], v[76:79], v[236:239]
    s_waitcnt vmcnt(2)
    s_waitcnt lgkmcnt(0)
    s_barrier
    ds_read_b128 v[64:67], v12 offset:32768
    v_mfma_f32_16x16x32_bf16 v[192:195], a[24:27], v[32:35], v[192:195]
    v_fma_f32 v88, v88, v240, v248
    ds_read_b64_tr_b16 a[48:49], v30 offset:0
    v_mfma_f32_16x16x32_bf16 v[208:211], v[32:35], a[88:91], v[208:211]
    v_fma_f32 v89, v89, v241, v249
    ds_read_b64_tr_b16 a[50:51], v30 offset:512
    v_mfma_f32_16x16x32_bf16 v[224:227], a[152:155], v[32:35], v[224:227]
    v_fma_f32 v90, v90, v242, v250
    ds_read_b128 v[68:71], v12 offset:36864
    v_mfma_f32_16x16x32_bf16 v[196:199], a[24:27], v[36:39], v[196:199]
    v_fma_f32 v91, v91, v243, v251
    ds_read_b64_tr_b16 a[112:113], v30 offset:16384
    v_mfma_f32_16x16x32_bf16 v[212:215], v[36:39], a[88:91], v[212:215]
    v_fma_f32 v92, v92, v244, v252
    ds_read_b64_tr_b16 a[114:115], v30 offset:16896
    v_mfma_f32_16x16x32_bf16 v[228:231], a[152:155], v[36:39], v[228:231]
    v_fma_f32 v93, v93, v245, v253
    ds_read_b128 v[72:75], v12 offset:40960
    v_mfma_f32_16x16x32_bf16 v[200:203], a[24:27], v[40:43], v[200:203]
    v_fma_f32 v94, v94, v246, v254
    v_fma_f32 v95, v95, v247, v255
    v_mfma_f32_16x16x32_bf16 v[216:219], v[40:43], a[88:91], v[216:219]
    v_cvt_pk_bf16_f32 v88, v88, v89
    ds_read_b64_tr_b16 a[176:177], v30 offset:32768
    v_mfma_f32_16x16x32_bf16 v[232:235], a[152:155], v[40:43], v[232:235]
    v_cvt_pk_bf16_f32 v89, v90, v91
    ds_read_b128 v[76:79], v12 offset:45056
    v_mfma_f32_16x16x32_bf16 v[204:207], a[24:27], v[44:47], v[204:207]
    v_cvt_pk_bf16_f32 v90, v92, v93
    ds_read_b64_tr_b16 a[178:179], v30 offset:33280
    v_mfma_f32_16x16x32_bf16 v[220:223], v[44:47], a[88:91], v[220:223]
    v_cvt_pk_bf16_f32 v91, v94, v95
    ds_read_b64_tr_b16 a[52:53], v30 offset:4096
    v_mfma_f32_16x16x32_bf16 v[236:239], a[152:155], v[44:47], v[236:239]
    ds_read_b128 v[32:35], v13 offset:32768
    v_mfma_f32_16x16x32_bf16 v[192:195], a[28:31], v[48:51], v[192:195]
    ds_write_b128 v16, v[88:91] offset:49152
    v_fma_f32 v120, v120, v240, v248
    v_mfma_f32_16x16x32_bf16 v[208:211], v[48:51], a[92:95], v[208:211]
    v_fma_f32 v121, v121, v241, v249
    v_fma_f32 v122, v122, v242, v250
    v_mfma_f32_16x16x32_bf16 v[224:227], a[156:159], v[48:51], v[224:227]
    v_fma_f32 v123, v123, v243, v251
    ds_read_b128 v[36:39], v13 offset:36864
    v_mfma_f32_16x16x32_bf16 v[196:199], a[28:31], v[52:55], v[196:199]
    v_fma_f32 v124, v124, v244, v252
    ds_read_b64_tr_b16 a[54:55], v30 offset:4608
    ds_read_b64_tr_b16 a[116:117], v30 offset:20480
    v_mfma_f32_16x16x32_bf16 v[212:215], v[52:55], a[92:95], v[212:215]
    v_fma_f32 v125, v125, v245, v253
    ds_read_b64_tr_b16 a[118:119], v30 offset:20992
    v_mfma_f32_16x16x32_bf16 v[228:231], a[156:159], v[52:55], v[228:231]
    v_fma_f32 v126, v126, v246, v254
    ds_read_b128 v[40:43], v13 offset:40960
    v_mfma_f32_16x16x32_bf16 v[200:203], a[28:31], v[56:59], v[200:203]
    v_fma_f32 v127, v127, v247, v255
    ds_read_b64_tr_b16 a[180:181], v30 offset:36864
    v_mfma_f32_16x16x32_bf16 v[216:219], v[56:59], a[92:95], v[216:219]
    v_cvt_pk_bf16_f32 v120, v120, v121
    v_cvt_pk_bf16_f32 v121, v122, v123
    v_mfma_f32_16x16x32_bf16 v[232:235], a[156:159], v[56:59], v[232:235]
    v_cvt_pk_bf16_f32 v122, v124, v125
    ds_read_b128 v[44:47], v13 offset:45056
    v_mfma_f32_16x16x32_bf16 v[204:207], a[28:31], v[60:63], v[204:207]
    v_cvt_pk_bf16_f32 v123, v126, v127
    ds_read_b64_tr_b16 a[182:183], v30 offset:37376
    v_mfma_f32_16x16x32_bf16 v[220:223], v[60:63], a[92:95], v[220:223]
    ds_write_b128 v17, v[120:123] offset:49152
    ds_read_b64_tr_b16 a[56:57], v30 offset:8192
    v_mfma_f32_16x16x32_bf16 v[236:239], a[156:159], v[60:63], v[236:239]
    ds_read_b128 v[48:51], v14 offset:32768
    s_waitcnt lgkmcnt(15)
    v_mfma_f32_16x16x32_bf16 v[192:195], a[32:35], v[64:67], v[192:195]
    v_fma_f32 v152, v152, v240, v248
    v_fma_f32 v153, v153, v241, v249
    v_mfma_f32_16x16x32_bf16 v[208:211], v[64:67], a[96:99], v[208:211]
    v_fma_f32 v154, v154, v242, v250
    v_fma_f32 v155, v155, v243, v251
    v_mfma_f32_16x16x32_bf16 v[224:227], a[160:163], v[64:67], v[224:227]
    v_fma_f32 v156, v156, v244, v252
    ds_read_b128 v[52:55], v14 offset:36864
    v_mfma_f32_16x16x32_bf16 v[196:199], a[32:35], v[68:71], v[196:199]
    v_fma_f32 v157, v157, v245, v253
    ds_read_b64_tr_b16 a[58:59], v30 offset:8704
    v_mfma_f32_16x16x32_bf16 v[212:215], v[68:71], a[96:99], v[212:215]
    v_fma_f32 v158, v158, v246, v254
    ds_read_b64_tr_b16 a[120:121], v30 offset:24576
    v_mfma_f32_16x16x32_bf16 v[228:231], a[160:163], v[68:71], v[228:231]
    v_fma_f32 v159, v159, v247, v255
    ds_read_b128 v[56:59], v14 offset:40960
    v_mfma_f32_16x16x32_bf16 v[200:203], a[32:35], v[72:75], v[200:203]
    v_cvt_pk_bf16_f32 v152, v152, v153
    ds_read_b64_tr_b16 a[122:123], v30 offset:25088
    ds_read_b64_tr_b16 a[184:185], v30 offset:40960
    v_mfma_f32_16x16x32_bf16 v[216:219], v[72:75], a[96:99], v[216:219]
    v_cvt_pk_bf16_f32 v153, v154, v155
    ds_read_b64_tr_b16 a[186:187], v30 offset:41472
    v_mfma_f32_16x16x32_bf16 v[232:235], a[160:163], v[72:75], v[232:235]
    v_cvt_pk_bf16_f32 v154, v156, v157
    ds_read_b128 v[60:63], v14 offset:45056
    v_mfma_f32_16x16x32_bf16 v[204:207], a[32:35], v[76:79], v[204:207]
    v_cvt_pk_bf16_f32 v155, v158, v159
    ds_write_b128 v18, v[152:155] offset:49152
    v_mfma_f32_16x16x32_bf16 v[220:223], v[76:79], a[96:99], v[220:223]
    v_fma_f32 v184, v184, v240, v248
    ds_read_b64_tr_b16 a[60:61], v30 offset:12288
    v_mfma_f32_16x16x32_bf16 v[236:239], a[160:163], v[76:79], v[236:239]
    ds_read_b128 v[64:67], v15 offset:32768
    s_waitcnt lgkmcnt(15)
    v_mfma_f32_16x16x32_bf16 v[192:195], a[36:39], v[32:35], v[192:195]
    v_fma_f32 v185, v185, v241, v249
    v_fma_f32 v186, v186, v242, v250
    v_mfma_f32_16x16x32_bf16 v[208:211], v[32:35], a[100:103], v[208:211]
    v_fma_f32 v187, v187, v243, v251
    ds_read_b64_tr_b16 a[62:63], v30 offset:12800
    v_mfma_f32_16x16x32_bf16 v[224:227], a[164:167], v[32:35], v[224:227]
    v_fma_f32 v188, v188, v244, v252
    ds_read_b128 v[68:71], v15 offset:36864
    v_mfma_f32_16x16x32_bf16 v[196:199], a[36:39], v[36:39], v[196:199]
    v_fma_f32 v189, v189, v245, v253
    v_fma_f32 v190, v190, v246, v254
    v_mfma_f32_16x16x32_bf16 v[212:215], v[36:39], a[100:103], v[212:215]
    v_fma_f32 v191, v191, v247, v255
    ds_read_b64_tr_b16 a[124:125], v30 offset:28672
    v_mfma_f32_16x16x32_bf16 v[228:231], a[164:167], v[36:39], v[228:231]
    v_cvt_pk_bf16_f32 v184, v184, v185
    ds_read_b128 v[72:75], v15 offset:40960
    v_mfma_f32_16x16x32_bf16 v[200:203], a[36:39], v[40:43], v[200:203]
    v_cvt_pk_bf16_f32 v185, v186, v187
    ds_read_b64_tr_b16 a[126:127], v30 offset:29184
    v_mfma_f32_16x16x32_bf16 v[216:219], v[40:43], a[100:103], v[216:219]
    v_cvt_pk_bf16_f32 v186, v188, v189
    ds_read_b64_tr_b16 a[188:189], v30 offset:45056
    v_mfma_f32_16x16x32_bf16 v[232:235], a[164:167], v[40:43], v[232:235]
    v_cvt_pk_bf16_f32 v187, v190, v191
    ds_read_b128 v[76:79], v15 offset:45056
    v_mfma_f32_16x16x32_bf16 v[204:207], a[36:39], v[44:47], v[204:207]
    ds_write_b128 v19, v[184:187] offset:49152
    ds_read_b64_tr_b16 a[190:191], v30 offset:45568
    v_mfma_f32_16x16x32_bf16 v[220:223], v[44:47], a[100:103], v[220:223]
    v_mfma_f32_16x16x32_bf16 v[236:239], a[164:167], v[44:47], v[236:239]
    s_waitcnt lgkmcnt(0)
    s_barrier
    ds_read_b128 v[32:35], v12 offset:49152
    v_mfma_f32_16x16x32_bf16 v[192:195], a[40:43], v[48:51], v[192:195]
    s_add_u32 m0, s43, 65536
    s_add_u32 s35, s42, 0
    v_mfma_f32_16x16x32_bf16 v[208:211], v[48:51], a[104:107], v[208:211]
    buffer_load_dwordx4 v24, s[56:59], s35 offen offset:0 lds
    v_mfma_f32_16x16x32_bf16 v[224:227], a[168:171], v[48:51], v[224:227]
    ds_read_b128 v[36:39], v12 offset:53248
    v_mfma_f32_16x16x32_bf16 v[196:199], a[40:43], v[52:55], v[196:199]
    buffer_load_dwordx4 v25, s[56:59], s35 offen offset:1024 lds
    v_mfma_f32_16x16x32_bf16 v[212:215], v[52:55], a[104:107], v[212:215]
    v_mfma_f32_16x16x32_bf16 v[228:231], a[168:171], v[52:55], v[228:231]
    buffer_load_dwordx4 v26, s[56:59], s35 offen offset:2048 lds
    ds_read_b128 v[40:43], v12 offset:57344
    v_mfma_f32_16x16x32_bf16 v[200:203], a[40:43], v[56:59], v[200:203]
    v_mfma_f32_16x16x32_bf16 v[216:219], v[56:59], a[104:107], v[216:219]
    v_mfma_f32_16x16x32_bf16 v[232:235], a[168:171], v[56:59], v[232:235]
    buffer_load_dwordx4 v27, s[56:59], s35 offen offset:3072 lds
    ds_read_b128 v[44:47], v12 offset:61440
    v_mfma_f32_16x16x32_bf16 v[204:207], a[40:43], v[60:63], v[204:207]
    v_mfma_f32_16x16x32_bf16 v[220:223], v[60:63], a[104:107], v[220:223]
    v_mfma_f32_16x16x32_bf16 v[236:239], a[168:171], v[60:63], v[236:239]
    ds_read_b128 v[48:51], v13 offset:49152
    v_mfma_f32_16x16x32_bf16 v[192:195], a[44:47], v[64:67], v[192:195]
    s_add_u32 m0, s43, 69632
    s_add_u32 s35, s42, 32768
    v_mfma_f32_16x16x32_bf16 v[208:211], v[64:67], a[108:111], v[208:211]
    buffer_load_dwordx4 v24, s[56:59], s35 offen offset:0 lds
    v_mfma_f32_16x16x32_bf16 v[224:227], a[172:175], v[64:67], v[224:227]
    buffer_load_dwordx4 v25, s[56:59], s35 offen offset:1024 lds
    ds_read_b128 v[52:55], v13 offset:53248
    v_mfma_f32_16x16x32_bf16 v[196:199], a[44:47], v[68:71], v[196:199]
    v_mfma_f32_16x16x32_bf16 v[212:215], v[68:71], a[108:111], v[212:215]
    v_mfma_f32_16x16x32_bf16 v[228:231], a[172:175], v[68:71], v[228:231]
    buffer_load_dwordx4 v26, s[56:59], s35 offen offset:2048 lds
    ds_read_b128 v[56:59], v13 offset:57344
    v_mfma_f32_16x16x32_bf16 v[200:203], a[44:47], v[72:75], v[200:203]
    v_mfma_f32_16x16x32_bf16 v[216:219], v[72:75], a[108:111], v[216:219]
    v_mfma_f32_16x16x32_bf16 v[232:235], a[172:175], v[72:75], v[232:235]
    buffer_load_dwordx4 v27, s[56:59], s35 offen offset:3072 lds
    ds_read_b128 v[60:63], v13 offset:61440
    v_mfma_f32_16x16x32_bf16 v[204:207], a[44:47], v[76:79], v[204:207]
    v_mfma_f32_16x16x32_bf16 v[220:223], v[76:79], a[108:111], v[220:223]
    v_mfma_f32_16x16x32_bf16 v[236:239], a[172:175], v[76:79], v[236:239]
    ds_read_b128 v[64:67], v14 offset:49152
    s_waitcnt lgkmcnt(5)
    v_mfma_f32_16x16x32_bf16 v[192:195], a[48:51], v[32:35], v[192:195]
    s_add_u32 m0, s43, 73728
    s_add_u32 s35, s42, 65536
    v_mfma_f32_16x16x32_bf16 v[208:211], v[32:35], a[112:115], v[208:211]
    buffer_load_dwordx4 v24, s[56:59], s35 offen offset:0 lds
    v_mfma_f32_16x16x32_bf16 v[224:227], a[176:179], v[32:35], v[224:227]
    buffer_load_dwordx4 v25, s[56:59], s35 offen offset:1024 lds
    ds_read_b128 v[68:71], v14 offset:53248
    v_mfma_f32_16x16x32_bf16 v[196:199], a[48:51], v[36:39], v[196:199]
    v_mfma_f32_16x16x32_bf16 v[212:215], v[36:39], a[112:115], v[212:215]
    v_mfma_f32_16x16x32_bf16 v[228:231], a[176:179], v[36:39], v[228:231]
    buffer_load_dwordx4 v26, s[56:59], s35 offen offset:2048 lds
    ds_read_b128 v[72:75], v14 offset:57344
    v_mfma_f32_16x16x32_bf16 v[200:203], a[48:51], v[40:43], v[200:203]
    v_mfma_f32_16x16x32_bf16 v[216:219], v[40:43], a[112:115], v[216:219]
    v_mfma_f32_16x16x32_bf16 v[232:235], a[176:179], v[40:43], v[232:235]
    buffer_load_dwordx4 v27, s[56:59], s35 offen offset:3072 lds
    ds_read_b128 v[76:79], v14 offset:61440
    v_mfma_f32_16x16x32_bf16 v[204:207], a[48:51], v[44:47], v[204:207]
    v_mfma_f32_16x16x32_bf16 v[220:223], v[44:47], a[112:115], v[220:223]
    v_mfma_f32_16x16x32_bf16 v[236:239], a[176:179], v[44:47], v[236:239]
    ds_read_b128 v[32:35], v15 offset:49152
    s_waitcnt lgkmcnt(5)
    v_mfma_f32_16x16x32_bf16 v[192:195], a[52:55], v[48:51], v[192:195]
    s_add_u32 m0, s43, 77824
    s_add_u32 s35, s42, 98304
    v_mfma_f32_16x16x32_bf16 v[208:211], v[48:51], a[116:119], v[208:211]
    buffer_load_dwordx4 v24, s[56:59], s35 offen offset:0 lds
    v_mfma_f32_16x16x32_bf16 v[224:227], a[180:183], v[48:51], v[224:227]
    buffer_load_dwordx4 v25, s[56:59], s35 offen offset:1024 lds
    ds_read_b128 v[36:39], v15 offset:53248
    v_mfma_f32_16x16x32_bf16 v[196:199], a[52:55], v[52:55], v[196:199]
    v_mfma_f32_16x16x32_bf16 v[212:215], v[52:55], a[116:119], v[212:215]
    v_mfma_f32_16x16x32_bf16 v[228:231], a[180:183], v[52:55], v[228:231]
    buffer_load_dwordx4 v26, s[56:59], s35 offen offset:2048 lds
    ds_read_b128 v[40:43], v15 offset:57344
    v_mfma_f32_16x16x32_bf16 v[200:203], a[52:55], v[56:59], v[200:203]
    v_mfma_f32_16x16x32_bf16 v[216:219], v[56:59], a[116:119], v[216:219]
    v_mfma_f32_16x16x32_bf16 v[232:235], a[180:183], v[56:59], v[232:235]
    buffer_load_dwordx4 v27, s[56:59], s35 offen offset:3072 lds
    ds_read_b128 v[44:47], v15 offset:61440
    v_mfma_f32_16x16x32_bf16 v[204:207], a[52:55], v[60:63], v[204:207]
    v_mfma_f32_16x16x32_bf16 v[220:223], v[60:63], a[116:119], v[220:223]
    v_mfma_f32_16x16x32_bf16 v[236:239], a[180:183], v[60:63], v[236:239]
    s_waitcnt lgkmcnt(4)
    v_mfma_f32_16x16x32_bf16 v[192:195], a[56:59], v[64:67], v[192:195]
    s_lshl_b32 s42, s39, 3
    s_mul_i32 s42, s42, 21846
    v_mfma_f32_16x16x32_bf16 v[208:211], v[64:67], a[120:123], v[208:211]
    s_lshr_b32 s42, s42, 16
    s_lshl_b32 s33, s42, 1
    v_mfma_f32_16x16x32_bf16 v[224:227], a[184:187], v[64:67], v[224:227]
    v_accvgpr_read_b32 v24, a240
    v_mfma_f32_16x16x32_bf16 v[196:199], a[56:59], v[68:71], v[196:199]
    v_accvgpr_read_b32 v25, a241
    v_accvgpr_read_b32 v26, a242
    v_mfma_f32_16x16x32_bf16 v[212:215], v[68:71], a[120:123], v[212:215]
    s_and_b32 s42, s5, 1
    s_mul_i32 s42, s42, 176128
    v_mfma_f32_16x16x32_bf16 v[228:231], a[184:187], v[68:71], v[228:231]
    s_lshl_b32 s43, s33, 5
    v_mfma_f32_16x16x32_bf16 v[200:203], a[56:59], v[72:75], v[200:203]
    s_add_u32 s42, s42, s43
    s_add_u32 s43, s38, 0
    v_mfma_f32_16x16x32_bf16 v[216:219], v[72:75], a[120:123], v[216:219]
    s_and_b32 s43, s43, 3
    s_mul_i32 s20, s43, 352256
    v_mfma_f32_16x16x32_bf16 v[232:235], a[184:187], v[72:75], v[232:235]
    s_add_u32 s20, s20, s42
    v_mfma_f32_16x16x32_bf16 v[204:207], a[56:59], v[76:79], v[204:207]
    s_lshl_b32 s16, s43, 12
    s_lshl_b32 s24, s43, 9
    v_mfma_f32_16x16x32_bf16 v[220:223], v[76:79], a[120:123], v[220:223]
    s_add_u32 s43, s38, 1
    s_and_b32 s43, s43, 3
    v_mfma_f32_16x16x32_bf16 v[236:239], a[184:187], v[76:79], v[236:239]
    s_mul_i32 s21, s43, 352256
    s_waitcnt lgkmcnt(0)
    v_mfma_f32_16x16x32_bf16 v[192:195], a[60:63], v[32:35], v[192:195]
    s_add_u32 s21, s21, s42
    s_lshl_b32 s17, s43, 12
    v_mfma_f32_16x16x32_bf16 v[208:211], v[32:35], a[124:127], v[208:211]
    s_lshl_b32 s25, s43, 9
    s_add_u32 s43, s38, 2
    v_mfma_f32_16x16x32_bf16 v[224:227], a[188:191], v[32:35], v[224:227]
    s_and_b32 s43, s43, 3
    v_mfma_f32_16x16x32_bf16 v[196:199], a[60:63], v[36:39], v[196:199]
    s_mul_i32 s22, s43, 352256
    s_add_u32 s22, s22, s42
    v_mfma_f32_16x16x32_bf16 v[212:215], v[36:39], a[124:127], v[212:215]
    s_lshl_b32 s18, s43, 12
    s_lshl_b32 s26, s43, 9
    v_mfma_f32_16x16x32_bf16 v[228:231], a[188:191], v[36:39], v[228:231]
    s_add_u32 s43, s38, 3
    v_mfma_f32_16x16x32_bf16 v[200:203], a[60:63], v[40:43], v[200:203]
    s_and_b32 s43, s43, 3
    s_mul_i32 s23, s43, 352256
    v_mfma_f32_16x16x32_bf16 v[216:219], v[40:43], a[124:127], v[216:219]
    s_add_u32 s23, s23, s42
    s_lshl_b32 s19, s43, 12
    v_mfma_f32_16x16x32_bf16 v[232:235], a[188:191], v[40:43], v[232:235]
    s_lshl_b32 s27, s43, 9
    v_mfma_f32_16x16x32_bf16 v[204:207], a[60:63], v[44:47], v[204:207]
    s_mul_i32 s42, s5, 12288
    v_accvgpr_read_b32 v28, a247
    v_mfma_f32_16x16x32_bf16 v[220:223], v[44:47], a[124:127], v[220:223]
    v_xor_b32 v29, 32, v28
    v_xor_b32 v30, 64, v28
    v_mfma_f32_16x16x32_bf16 v[236:239], a[188:191], v[44:47], v[236:239]
    v_xor_b32 v31, 96, v28
    s_barrier
    v_cvt_pk_bf16_f32 v96, v192, v193
    s_add_u32 m0, s42, 0
    s_add_u32 s35, s20, 0
    v_cvt_pk_bf16_f32 v97, v194, v195
    buffer_load_dwordx4 v24, s[72:75], s35 offen offset:0 lds
    v_cvt_pk_bf16_f32 v98, v196, v197
    v_cvt_pk_bf16_f32 v99, v198, v199
    v_cvt_pk_bf16_f32 v100, v200, v201
    v_cvt_pk_bf16_f32 v101, v202, v203
    v_cvt_pk_bf16_f32 v102, v204, v205
    v_cvt_pk_bf16_f32 v103, v206, v207
    v_permlane16_swap_b32 v96, v98
    v_permlane16_swap_b32 v97, v99
    v_permlane16_swap_b32 v100, v102
    v_permlane16_swap_b32 v101, v103
    v_mfma_f32_32x32x16_bf16 v[64:79], v[136:139], v[96:99], 0
    buffer_load_dwordx4 v25, s[72:75], s35 offen offset:1024 lds
    v_mfma_f32_32x32x16_bf16 v[80:95], v[136:139], v[100:103], 0
    v_cvt_pk_bf16_f32 v160, v208, v209
    v_cvt_pk_bf16_f32 v161, v210, v211
    v_cvt_pk_bf16_f32 v162, v212, v213
    v_cvt_pk_bf16_f32 v163, v214, v215
    v_cvt_pk_bf16_f32 v164, v216, v217
    v_cvt_pk_bf16_f32 v165, v218, v219
    v_cvt_pk_bf16_f32 v166, v220, v221
    v_cvt_pk_bf16_f32 v167, v222, v223
    s_nop 1
    v_max3_f32 v104, v64, v65, v66
    v_max3_f32 v105, v67, v68, v69
    buffer_load_dwordx4 v26, s[72:75], s35 offen offset:2048 lds
    v_max3_f32 v106, v70, v71, v72
    v_max3_f32 v107, v73, v74, v75
    v_max3_f32 v108, v76, v77, v78
    v_max3_f32 v104, v104, v105, v106
    v_max3_f32 v107, v107, v108, v79
    v_max3_f32 v112, v80, v81, v82
    v_max_f32 v104, v104, v107
    v_max3_f32 v113, v83, v84, v85
    v_mul_f32 v104, s96, v104
    v_max3_f32 v114, v86, v87, v88
    v_pk_fma_f32 v[64:65], v[64:65], s[94:95], v[104:105] op_sel_hi:[1,1,0]
    v_max3_f32 v115, v89, v90, v91
    v_pk_fma_f32 v[66:67], v[66:67], s[94:95], v[104:105] op_sel_hi:[1,1,0]
    s_add_u32 m0, s42, 3072
    v_max3_f32 v116, v92, v93, v94
    s_add_u32 s35, s20, 44032
    v_pk_fma_f32 v[68:69], v[68:69], s[94:95], v[104:105] op_sel_hi:[1,1,0]
    buffer_load_dwordx4 v24, s[72:75], s35 offen offset:0 lds
    v_max3_f32 v112, v112, v113, v114
    v_pk_fma_f32 v[70:71], v[70:71], s[94:95], v[104:105] op_sel_hi:[1,1,0]
    v_max3_f32 v115, v115, v116, v95
    v_pk_fma_f32 v[72:73], v[72:73], s[94:95], v[104:105] op_sel_hi:[1,1,0]
    v_max_f32 v112, v112, v115
    v_pk_fma_f32 v[74:75], v[74:75], s[94:95], v[104:105] op_sel_hi:[1,1,0]
    v_mul_f32 v112, s96, v112
    v_pk_fma_f32 v[76:77], v[76:77], s[94:95], v[104:105] op_sel_hi:[1,1,0]
    v_pk_fma_f32 v[80:81], v[80:81], s[94:95], v[112:113] op_sel_hi:[1,1,0]
    v_pk_fma_f32 v[78:79], v[78:79], s[94:95], v[104:105] op_sel_hi:[1,1,0]
    v_pk_fma_f32 v[82:83], v[82:83], s[94:95], v[112:113] op_sel_hi:[1,1,0]
    v_exp_f32 v64, v64
    buffer_load_dwordx4 v25, s[72:75], s35 offen offset:1024 lds
    v_pk_fma_f32 v[84:85], v[84:85], s[94:95], v[112:113] op_sel_hi:[1,1,0]
    v_exp_f32 v65, v65
    v_pk_fma_f32 v[86:87], v[86:87], s[94:95], v[112:113] op_sel_hi:[1,1,0]
    v_exp_f32 v66, v66
    v_pk_fma_f32 v[88:89], v[88:89], s[94:95], v[112:113] op_sel_hi:[1,1,0]
    v_exp_f32 v67, v67
    v_pk_fma_f32 v[90:91], v[90:91], s[94:95], v[112:113] op_sel_hi:[1,1,0]
    v_exp_f32 v68, v68
    v_pk_fma_f32 v[92:93], v[92:93], s[94:95], v[112:113] op_sel_hi:[1,1,0]
    v_exp_f32 v69, v69
    buffer_load_dwordx4 v26, s[72:75], s35 offen offset:2048 lds
    v_pk_fma_f32 v[94:95], v[94:95], s[94:95], v[112:113] op_sel_hi:[1,1,0]
    v_exp_f32 v70, v70
    v_exp_f32 v80, v80
    v_exp_f32 v71, v71
    v_exp_f32 v81, v81
    v_exp_f32 v72, v72
    v_exp_f32 v82, v82
    v_exp_f32 v73, v73
    s_add_u32 m0, s42, 6144
    v_exp_f32 v83, v83
    s_add_u32 s35, s20, 88064
    buffer_load_dwordx4 v24, s[72:75], s35 offen offset:0 lds
    v_exp_f32 v74, v74
    v_exp_f32 v84, v84
    v_exp_f32 v75, v75
    v_exp_f32 v85, v85
    v_exp_f32 v76, v76
    v_exp_f32 v86, v86
    v_exp_f32 v77, v77
    v_exp_f32 v87, v87
    buffer_load_dwordx4 v25, s[72:75], s35 offen offset:1024 lds
    v_exp_f32 v78, v78
    v_exp_f32 v88, v88
    v_exp_f32 v79, v79
    v_exp_f32 v89, v89
    v_pk_add_f32 v[104:105], v[64:65], v[66:67]
    v_exp_f32 v90, v90
    v_pk_add_f32 v[106:107], v[68:69], v[70:71]
    v_exp_f32 v91, v91
    buffer_load_dwordx4 v26, s[72:75], s35 offen offset:2048 lds
    v_pk_add_f32 v[108:109], v[72:73], v[74:75]
    v_exp_f32 v92, v92
    v_pk_add_f32 v[110:111], v[76:77], v[78:79]
    v_exp_f32 v93, v93
    v_pk_add_f32 v[104:105], v[104:105], v[106:107]
    v_exp_f32 v94, v94
    v_pk_add_f32 v[108:109], v[108:109], v[110:111]
    v_exp_f32 v95, v95
    v_pk_add_f32 v[104:105], v[104:105], v[108:109]
    v_pk_add_f32 v[112:113], v[80:81], v[82:83]
    s_add_u32 m0, s42, 9216
    v_add_f32 v104, v104, v105
    s_add_u32 s35, s20, 132096
    v_pk_add_f32 v[114:115], v[84:85], v[86:87]
    buffer_load_dwordx4 v24, s[72:75], s35 offen offset:0 lds
    v_rcp_f32 v104, v104
    v_pk_add_f32 v[116:117], v[88:89], v[90:91]
    v_pk_mul_f32 v[64:65], v[64:65], v[104:105] op_sel_hi:[1,0]
    v_pk_add_f32 v[118:119], v[92:93], v[94:95]
    v_pk_mul_f32 v[66:67], v[66:67], v[104:105] op_sel_hi:[1,0]
    v_pk_add_f32 v[112:113], v[112:113], v[114:115]
    v_pk_mul_f32 v[68:69], v[68:69], v[104:105] op_sel_hi:[1,0]
    v_pk_add_f32 v[116:117], v[116:117], v[118:119]
    v_pk_mul_f32 v[70:71], v[70:71], v[104:105] op_sel_hi:[1,0]
    v_pk_add_f32 v[112:113], v[112:113], v[116:117]
    v_pk_mul_f32 v[72:73], v[72:73], v[104:105] op_sel_hi:[1,0]
    v_add_f32 v112, v112, v113
    buffer_load_dwordx4 v25, s[72:75], s35 offen offset:1024 lds
    v_pk_mul_f32 v[74:75], v[74:75], v[104:105] op_sel_hi:[1,0]
    v_rcp_f32 v112, v112
    v_pk_mul_f32 v[76:77], v[76:77], v[104:105] op_sel_hi:[1,0]
    v_pk_mul_f32 v[80:81], v[80:81], v[112:113] op_sel_hi:[1,0]
    v_pk_mul_f32 v[78:79], v[78:79], v[104:105] op_sel_hi:[1,0]
    v_pk_mul_f32 v[82:83], v[82:83], v[112:113] op_sel_hi:[1,0]
    v_cvt_pk_bf16_f32 v144, v64, v65
    v_pk_mul_f32 v[84:85], v[84:85], v[112:113] op_sel_hi:[1,0]
    v_cvt_pk_bf16_f32 v145, v66, v67
    v_pk_mul_f32 v[86:87], v[86:87], v[112:113] op_sel_hi:[1,0]
    v_cvt_pk_bf16_f32 v146, v68, v69
    v_pk_mul_f32 v[88:89], v[88:89], v[112:113] op_sel_hi:[1,0]
    v_cvt_pk_bf16_f32 v147, v70, v71
    buffer_load_dwordx4 v26, s[72:75], s35 offen offset:2048 lds
    v_pk_mul_f32 v[90:91], v[90:91], v[112:113] op_sel_hi:[1,0]
    v_cvt_pk_bf16_f32 v148, v72, v73
    v_pk_mul_f32 v[92:93], v[92:93], v[112:113] op_sel_hi:[1,0]
    v_cvt_pk_bf16_f32 v149, v74, v75
    v_pk_mul_f32 v[94:95], v[94:95], v[112:113] op_sel_hi:[1,0]
    v_cvt_pk_bf16_f32 v150, v76, v77
    v_cvt_pk_bf16_f32 v152, v80, v81
    v_cvt_pk_bf16_f32 v151, v78, v79
    v_cvt_pk_bf16_f32 v153, v82, v83
    v_cvt_pk_bf16_f32 v154, v84, v85
    v_cvt_pk_bf16_f32 v155, v86, v87
    v_cvt_pk_bf16_f32 v156, v88, v89
    v_cvt_pk_bf16_f32 v157, v90, v91
    v_cvt_pk_bf16_f32 v158, v92, v93
    v_cvt_pk_bf16_f32 v159, v94, v95
    ds_write_b128 v8, v[144:147] offset:0
    ds_write_b128 v143, v[148:151] offset:0
    ds_write_b128 v8, v[152:155] offset:2048
    ds_write_b128 v143, v[156:159] offset:2048
    ds_read_b64_tr_b16 v[64:65], v9 offset:0
    ds_read_b64_tr_b16 v[66:67], v9 offset:1024
    ds_read_b64_tr_b16 v[68:69], v9 offset:2048
    ds_read_b64_tr_b16 v[70:71], v9 offset:3072
    ds_read_b64_tr_b16 v[72:73], v10 offset:0
    ds_read_b64_tr_b16 v[74:75], v10 offset:1024
    ds_read_b64_tr_b16 v[76:77], v10 offset:2048
    ds_read_b64_tr_b16 v[78:79], v10 offset:3072
    s_lshl_b32 s11, s34, 5
    s_add_u32 s11, s11, s8
    s_mul_i32 s11, s11, 2176
    s_add_u32 s11, s11, 1048576
    v_lshlrev_b32 v8, 5, v2
    v_lshl_add_u32 v8, v3, 4, v8
    v_mov_b32 v9, 2147483632
    v_cmp_gt_u32 vcc, 2, v3
    s_nop 1
    v_cndmask_b32 v8, v9, v8, vcc
    v_cmp_eq_u32 vcc, 1, v3
    s_waitcnt lgkmcnt(0)
    v_mfma_f32_16x16x32_bf16 v[172:175], v[64:67], v[160:163], 0
    v_mfma_f32_16x16x32_bf16 v[176:179], v[72:75], v[160:163], 0
    v_mfma_f32_16x16x32_bf16 v[172:175], v[68:71], v[164:167], v[172:175]
    v_mfma_f32_16x16x32_bf16 v[176:179], v[76:79], v[164:167], v[176:179]
    v_mfma_f32_16x16x32_bf16 v[180:183], v[64:67], v[168:171], 0
    v_mfma_f32_16x16x32_bf16 v[184:187], v[72:75], v[168:171], 0
    v_mfma_f32_16x16x32_bf16 v[180:183], v[68:71], v[168:171], v[180:183]
    v_mfma_f32_16x16x32_bf16 v[184:187], v[76:79], v[168:171], v[184:187]
    s_nop 2
    v_perm_b32 v172, v172, v4, s88
    v_perm_b32 v173, v173, v4, s89
    v_perm_b32 v174, v174, v4, s90
    v_perm_b32 v175, v175, v4, s91
    v_perm_b32 v176, v176, v4, s88
    v_perm_b32 v177, v177, v4, s89
    v_perm_b32 v178, v178, v4, s90
    v_perm_b32 v179, v179, v4, s91
    buffer_store_dwordx4 v[172:175], v5, s[84:87], s11 offen sc1
    buffer_store_dwordx4 v[176:179], v5, s[84:87], s11 offen offset:1024 sc1
    v_cndmask_b32 v180, v180, v184, vcc
    v_cndmask_b32 v181, v181, v185, vcc
    v_cndmask_b32 v182, v182, v186, vcc
    v_cndmask_b32 v183, v183, v187, vcc
    v_perm_b32 v180, v180, v4, s88
    v_perm_b32 v181, v181, v4, s89
    v_perm_b32 v182, v182, v4, s90
    v_perm_b32 v183, v183, v4, s91
    buffer_store_dwordx4 v[180:183], v8, s[84:87], s11 offen offset:2048 sc1
    s_waitcnt vmcnt(15)
    ds_read_b64_tr_b16 a[192:193], v28 offset:0
    ds_read_b64_tr_b16 a[194:195], v28 offset:2048
    ds_read_b64_tr_b16 a[196:197], v29 offset:0
    ds_read_b64_tr_b16 a[198:199], v29 offset:2048
    ds_read_b64_tr_b16 a[200:201], v30 offset:0
    ds_read_b64_tr_b16 a[202:203], v30 offset:2048
    ds_read_b64_tr_b16 a[204:205], v31 offset:0
    ds_read_b64_tr_b16 a[206:207], v31 offset:2048
    ds_read_b64_tr_b16 a[208:209], v28 offset:4096
    ds_read_b64_tr_b16 a[210:211], v28 offset:6144
    ds_read_b64_tr_b16 a[212:213], v29 offset:4096
    ds_read_b64_tr_b16 a[214:215], v29 offset:6144
    ds_read_b64_tr_b16 a[216:217], v30 offset:4096
    ds_read_b64_tr_b16 a[218:219], v30 offset:6144
    ds_read_b64_tr_b16 a[220:221], v31 offset:4096
    ds_read_b64_tr_b16 a[222:223], v31 offset:6144
    ds_read_b64_tr_b16 a[224:225], v28 offset:8192
    ds_read_b64_tr_b16 a[226:227], v28 offset:10240
    ds_read_b64_tr_b16 a[228:229], v29 offset:8192
    ds_read_b64_tr_b16 a[230:231], v29 offset:10240
    ds_read_b64_tr_b16 a[232:233], v30 offset:8192
    ds_read_b64_tr_b16 a[234:235], v30 offset:10240
    ds_read_b64_tr_b16 a[236:237], v31 offset:8192
    ds_read_b64_tr_b16 a[238:239], v31 offset:10240
    ds_read_b64_tr_b16 a[240:241], v28 offset:12288
    ds_read_b64_tr_b16 a[242:243], v28 offset:14336
    ds_read_b64_tr_b16 a[244:245], v29 offset:12288
    ds_read_b64_tr_b16 a[246:247], v29 offset:14336
    ds_read_b64_tr_b16 a[248:249], v30 offset:12288
    ds_read_b64_tr_b16 a[250:251], v30 offset:14336
    ds_read_b64_tr_b16 a[252:253], v31 offset:12288
    ds_read_b64_tr_b16 a[254:255], v31 offset:14336
    s_waitcnt lgkmcnt(0)
    s_barrier
    v_cvt_pk_bf16_f32 v96, v224, v225
    s_add_u32 m0, s42, 65536
    s_add_u32 s35, s21, 0
    buffer_load_dwordx4 v24, s[72:75], s35 offen offset:0 lds
    v_cvt_pk_bf16_f32 v97, v226, v227
    v_cvt_pk_bf16_f32 v98, v228, v229
    v_cvt_pk_bf16_f32 v99, v230, v231
    v_cvt_pk_bf16_f32 v100, v232, v233
    v_cvt_pk_bf16_f32 v101, v234, v235
    v_cvt_pk_bf16_f32 v102, v236, v237
    v_cvt_pk_bf16_f32 v103, v238, v239
    v_permlane16_swap_b32 v96, v98
    v_permlane16_swap_b32 v97, v99
    buffer_load_dwordx4 v25, s[72:75], s35 offen offset:1024 lds
    v_permlane16_swap_b32 v100, v102
    v_permlane16_swap_b32 v101, v103
    v_mfma_f32_32x32x16_bf16 v[64:79], v[136:139], v[96:99], 0
    s_nop 0
    v_mfma_f32_32x32x16_bf16 v[80:95], v[136:139], v[100:103], 0
    buffer_load_dwordx4 v26, s[72:75], s35 offen offset:2048 lds
    s_lshl_b32 s11, s8, 7
    s_add_u32 s11, s11, s34
    s_lshl_b32 s11, s11, 10
    s_add_u32 s11, s11, 4194304
    s_lshl_b32 s12, s8, 3
    s_add_u32 s12, s12, s7
    s_lshl_b32 s12, s12, 7
    s_add_u32 s12, s12, 524288
    s_add_u32 m0, s42, 68608
    v_and_b32 v6, 1, v2
    s_add_u32 s35, s21, 44032
    buffer_load_dwordx4 v24, s[72:75], s35 offen offset:0 lds
    v_lshlrev_b32 v6, 15, v6
    v_lshrrev_b32 v7, 1, v2
    v_lshl_add_u32 v6, v7, 9, v6
    v_lshl_add_u32 v6, v3, 4, v6
    v_max3_f32 v104, v64, v65, v66
    v_max3_f32 v105, v67, v68, v69
    v_max3_f32 v106, v70, v71, v72
    v_max3_f32 v107, v73, v74, v75
    v_max3_f32 v108, v76, v77, v78
    buffer_load_dwordx4 v25, s[72:75], s35 offen offset:1024 lds
    v_max3_f32 v104, v104, v105, v106
    v_max3_f32 v107, v107, v108, v79
    v_max3_f32 v112, v80, v81, v82
    v_max_f32 v104, v104, v107
    v_max3_f32 v113, v83, v84, v85
    v_mul_f32 v104, s96, v104
    v_max3_f32 v114, v86, v87, v88
    v_pk_fma_f32 v[64:65], v[64:65], s[94:95], v[104:105] op_sel_hi:[1,1,0]
    v_max3_f32 v115, v89, v90, v91
    buffer_load_dwordx4 v26, s[72:75], s35 offen offset:2048 lds
    v_pk_fma_f32 v[66:67], v[66:67], s[94:95], v[104:105] op_sel_hi:[1,1,0]
    v_max3_f32 v116, v92, v93, v94
    v_pk_fma_f32 v[68:69], v[68:69], s[94:95], v[104:105] op_sel_hi:[1,1,0]
    v_max3_f32 v112, v112, v113, v114
    v_pk_fma_f32 v[70:71], v[70:71], s[94:95], v[104:105] op_sel_hi:[1,1,0]
    v_max3_f32 v115, v115, v116, v95
    v_pk_fma_f32 v[72:73], v[72:73], s[94:95], v[104:105] op_sel_hi:[1,1,0]
    v_max_f32 v112, v112, v115
    s_add_u32 m0, s42, 71680
    v_pk_fma_f32 v[74:75], v[74:75], s[94:95], v[104:105] op_sel_hi:[1,1,0]
    s_add_u32 s35, s21, 88064
    buffer_load_dwordx4 v24, s[72:75], s35 offen offset:0 lds
    v_mul_f32 v112, s96, v112
    v_pk_fma_f32 v[76:77], v[76:77], s[94:95], v[104:105] op_sel_hi:[1,1,0]
    v_pk_fma_f32 v[80:81], v[80:81], s[94:95], v[112:113] op_sel_hi:[1,1,0]
    v_pk_fma_f32 v[78:79], v[78:79], s[94:95], v[104:105] op_sel_hi:[1,1,0]
    v_pk_fma_f32 v[82:83], v[82:83], s[94:95], v[112:113] op_sel_hi:[1,1,0]
    v_exp_f32 v64, v64
    v_pk_fma_f32 v[84:85], v[84:85], s[94:95], v[112:113] op_sel_hi:[1,1,0]
    v_exp_f32 v65, v65
    buffer_load_dwordx4 v25, s[72:75], s35 offen offset:1024 lds
    v_pk_fma_f32 v[86:87], v[86:87], s[94:95], v[112:113] op_sel_hi:[1,1,0]
    v_exp_f32 v66, v66
    v_pk_fma_f32 v[88:89], v[88:89], s[94:95], v[112:113] op_sel_hi:[1,1,0]
    v_exp_f32 v67, v67
    v_pk_fma_f32 v[90:91], v[90:91], s[94:95], v[112:113] op_sel_hi:[1,1,0]
    v_exp_f32 v68, v68
    buffer_load_dwordx4 v26, s[72:75], s35 offen offset:2048 lds
    v_pk_fma_f32 v[92:93], v[92:93], s[94:95], v[112:113] op_sel_hi:[1,1,0]
    v_exp_f32 v69, v69
    v_pk_fma_f32 v[94:95], v[94:95], s[94:95], v[112:113] op_sel_hi:[1,1,0]
    v_exp_f32 v70, v70
    v_exp_f32 v80, v80
    v_exp_f32 v71, v71
    s_add_u32 m0, s42, 74752
    s_add_u32 s35, s21, 132096
    buffer_load_dwordx4 v24, s[72:75], s35 offen offset:0 lds
    v_exp_f32 v81, v81
    v_exp_f32 v72, v72
    v_exp_f32 v82, v82
    v_exp_f32 v73, v73
    v_exp_f32 v83, v83
    buffer_load_dwordx4 v25, s[72:75], s35 offen offset:1024 lds
    v_exp_f32 v74, v74
    v_exp_f32 v84, v84
    v_exp_f32 v75, v75
    v_exp_f32 v85, v85
    v_exp_f32 v76, v76
    buffer_load_dwordx4 v26, s[72:75], s35 offen offset:2048 lds
    v_exp_f32 v86, v86
    v_exp_f32 v77, v77
    v_exp_f32 v87, v87
    v_exp_f32 v78, v78
    v_exp_f32 v88, v88
    v_exp_f32 v79, v79
    v_exp_f32 v89, v89
    s_add_u32 s13, s29, 0
    v_pk_add_f32 v[104:105], v[64:65], v[66:67]
    v_exp_f32 v90, v90
    buffer_load_dwordx4 v[172:175], v130, s[84:87], s13 offen sc1
    v_pk_add_f32 v[106:107], v[68:69], v[70:71]
    v_exp_f32 v91, v91
    s_add_u32 s13, s29, 17408
    v_pk_add_f32 v[108:109], v[72:73], v[74:75]
    v_exp_f32 v92, v92
    buffer_load_dwordx4 v[176:179], v130, s[84:87], s13 offen sc1
    v_pk_add_f32 v[110:111], v[76:77], v[78:79]
    v_exp_f32 v93, v93
    s_add_u32 s13, s29, 34816
    v_pk_add_f32 v[104:105], v[104:105], v[106:107]
    v_exp_f32 v94, v94
    buffer_load_dwordx4 v[180:183], v130, s[84:87], s13 offen sc1
    v_pk_add_f32 v[108:109], v[108:109], v[110:111]
    v_exp_f32 v95, v95
    s_add_u32 s13, s29, 52224
    v_pk_add_f32 v[104:105], v[104:105], v[108:109]
    v_pk_add_f32 v[112:113], v[80:81], v[82:83]
    v_add_f32 v104, v104, v105
    buffer_load_dwordx4 v[184:187], v130, s[84:87], s13 offen sc1
    v_pk_add_f32 v[114:115], v[84:85], v[86:87]
    v_rcp_f32 v104, v104
    v_pk_add_f32 v[116:117], v[88:89], v[90:91]
    v_pk_mul_f32 v[64:65], v[64:65], v[104:105] op_sel_hi:[1,0]
    v_pk_add_f32 v[118:119], v[92:93], v[94:95]
    v_pk_mul_f32 v[66:67], v[66:67], v[104:105] op_sel_hi:[1,0]
    v_pk_add_f32 v[112:113], v[112:113], v[114:115]
    v_pk_mul_f32 v[68:69], v[68:69], v[104:105] op_sel_hi:[1,0]
    v_pk_add_f32 v[116:117], v[116:117], v[118:119]
    v_pk_mul_f32 v[70:71], v[70:71], v[104:105] op_sel_hi:[1,0]
    v_pk_add_f32 v[112:113], v[112:113], v[116:117]
    v_pk_mul_f32 v[72:73], v[72:73], v[104:105] op_sel_hi:[1,0]
    v_add_f32 v112, v112, v113
    v_pk_mul_f32 v[74:75], v[74:75], v[104:105] op_sel_hi:[1,0]
    v_rcp_f32 v112, v112
    v_pk_mul_f32 v[76:77], v[76:77], v[104:105] op_sel_hi:[1,0]
    v_pk_mul_f32 v[80:81], v[80:81], v[112:113] op_sel_hi:[1,0]
    v_pk_mul_f32 v[78:79], v[78:79], v[104:105] op_sel_hi:[1,0]
    v_pk_mul_f32 v[82:83], v[82:83], v[112:113] op_sel_hi:[1,0]
    v_cvt_pk_bf16_f32 v144, v64, v65
    v_pk_mul_f32 v[84:85], v[84:85], v[112:113] op_sel_hi:[1,0]
    v_cvt_pk_bf16_f32 v145, v66, v67
    v_pk_mul_f32 v[86:87], v[86:87], v[112:113] op_sel_hi:[1,0]
    v_cvt_pk_bf16_f32 v146, v68, v69
    v_pk_mul_f32 v[88:89], v[88:89], v[112:113] op_sel_hi:[1,0]
    v_cvt_pk_bf16_f32 v147, v70, v71
    v_pk_mul_f32 v[90:91], v[90:91], v[112:113] op_sel_hi:[1,0]
    v_cvt_pk_bf16_f32 v148, v72, v73
    v_pk_mul_f32 v[92:93], v[92:93], v[112:113] op_sel_hi:[1,0]
    v_cvt_pk_bf16_f32 v149, v74, v75
    v_pk_mul_f32 v[94:95], v[94:95], v[112:113] op_sel_hi:[1,0]
    v_cvt_pk_bf16_f32 v150, v76, v77
    v_cvt_pk_bf16_f32 v152, v80, v81
    v_cvt_pk_bf16_f32 v151, v78, v79
    v_cvt_pk_bf16_f32 v153, v82, v83
    v_cvt_pk_bf16_f32 v154, v84, v85
    v_cvt_pk_bf16_f32 v155, v86, v87
    v_cvt_pk_bf16_f32 v156, v88, v89
    v_cvt_pk_bf16_f32 v157, v90, v91
    v_cvt_pk_bf16_f32 v158, v92, v93
    v_cvt_pk_bf16_f32 v159, v94, v95
    buffer_store_dwordx4 v[144:147], v6, s[84:87], s11 offen sc1
    buffer_store_dwordx4 v[148:151], v6, s[84:87], s11 offen offset:256 sc1
    s_add_u32 s11, s11, 65536
    buffer_store_dwordx4 v[152:155], v6, s[84:87], s11 offen sc1
    buffer_store_dwordx4 v[156:159], v6, s[84:87], s11 offen offset:256 sc1
    s_waitcnt vmcnt(4)
    v_perm_b32 v9, v173, v172, s92
    v_perm_b32 v10, v175, v174, s93
    v_bitop3_b32 v8, v9, v10, v4 bitop3:0x96
    v_perm_b32 v9, v177, v176, s92
    v_perm_b32 v10, v179, v178, s93
    v_bitop3_b32 v9, v9, v10, v4 bitop3:0x96
    v_or_b32 v8, v8, v9
    v_perm_b32 v9, v181, v180, s92
    v_perm_b32 v10, v183, v182, s93
    v_bitop3_b32 v9, v9, v10, v4 bitop3:0x96
    v_or_b32 v8, v8, v9
    v_perm_b32 v9, v185, v184, s92
    v_perm_b32 v10, v187, v186, s93
    v_bitop3_b32 v9, v9, v10, v4 bitop3:0x96
    v_or_b32 v8, v8, v9
    v_cmp_ne_u32 vcc, 0, v8
    s_cbranch_vccz Ldone_4
    s_mov_b32 s15, 0
    s_nop 3
Lspin_3:
    s_add_u32 s13, s29, 0
    buffer_load_dwordx4 v[172:175], v130, s[84:87], s13 offen sc1
    s_add_u32 s13, s29, 17408
    buffer_load_dwordx4 v[176:179], v130, s[84:87], s13 offen sc1
    s_add_u32 s13, s29, 34816
    buffer_load_dwordx4 v[180:183], v130, s[84:87], s13 offen sc1
    s_add_u32 s13, s29, 52224
    buffer_load_dwordx4 v[184:187], v130, s[84:87], s13 offen sc1
    s_waitcnt vmcnt(0)
    v_perm_b32 v9, v173, v172, s92
    v_perm_b32 v10, v175, v174, s93
    v_bitop3_b32 v8, v9, v10, v4 bitop3:0x96
    v_perm_b32 v9, v177, v176, s92
    v_perm_b32 v10, v179, v178, s93
    v_bitop3_b32 v9, v9, v10, v4 bitop3:0x96
    v_or_b32 v8, v8, v9
    v_perm_b32 v9, v181, v180, s92
    v_perm_b32 v10, v183, v182, s93
    v_bitop3_b32 v9, v9, v10, v4 bitop3:0x96
    v_or_b32 v8, v8, v9
    v_perm_b32 v9, v185, v184, s92
    v_perm_b32 v10, v187, v186, s93
    v_bitop3_b32 v9, v9, v10, v4 bitop3:0x96
    v_or_b32 v8, v8, v9
    v_cmp_ne_u32 vcc, 0, v8
    s_cbranch_vccz Ldone_4
    s_add_u32 s15, s15, 1
    s_cmp_lt_u32 s15, 400000
    s_cbranch_scc1 Lspin_3
Ldone_4:
    s_nop 1
    v_and_b32 v172, s31, v172
    v_and_b32 v173, s31, v173
    v_and_b32 v174, s31, v174
    v_and_b32 v175, s31, v175
    v_and_b32 v176, s31, v176
    v_and_b32 v177, s31, v177
    v_and_b32 v178, s31, v178
    v_and_b32 v179, s31, v179
    v_and_b32 v180, s31, v180
    v_and_b32 v181, s31, v181
    v_and_b32 v182, s31, v182
    v_and_b32 v183, s31, v183
    v_and_b32 v184, s31, v184
    v_and_b32 v185, s31, v185
    v_and_b32 v186, s31, v186
    v_and_b32 v187, s31, v187
    v_pk_add_f32 v[172:173], v[172:173], v[180:181]
    v_pk_add_f32 v[174:175], v[174:175], v[182:183]
    v_pk_add_f32 v[176:177], v[176:177], v[184:185]
    v_pk_add_f32 v[178:179], v[178:179], v[186:187]
    v_pk_add_f32 v[172:173], v[172:173], v[176:177]
    v_pk_add_f32 v[174:175], v[174:175], v[178:179]
    s_nop 0
    v_add_f32_dpp v172, v172, v172 row_ror:8 row_mask:0xf bank_mask:0xf
    v_add_f32_dpp v173, v173, v173 row_ror:8 row_mask:0xf bank_mask:0xf
    v_add_f32_dpp v174, v174, v174 row_ror:8 row_mask:0xf bank_mask:0xf
    v_add_f32_dpp v175, v175, v175 row_ror:8 row_mask:0xf bank_mask:0xf
    v_mov_b32 v176, v172
    v_mov_b32 v177, v173
    v_mov_b32 v178, v174
    v_mov_b32 v179, v175
    v_permlane16_swap_b32 v172, v176
    v_permlane16_swap_b32 v173, v177
    v_permlane16_swap_b32 v174, v178
    v_permlane16_swap_b32 v175, v179
    v_pk_add_f32 v[172:173], v[172:173], v[176:177]
    v_pk_add_f32 v[174:175], v[174:175], v[178:179]
    v_mov_b32 v176, v172
    v_mov_b32 v177, v173
    v_mov_b32 v178, v174
    v_mov_b32 v179, v175
    v_permlane32_swap_b32 v172, v176
    v_permlane32_swap_b32 v173, v177
    v_permlane32_swap_b32 v174, v178
    v_permlane32_swap_b32 v175, v179
    v_pk_add_f32 v[172:173], v[172:173], v[176:177]
    v_pk_add_f32 v[174:175], v[174:175], v[178:179]
    v_cvt_pk_bf16_f32 v176, v172, v173
    v_cvt_pk_bf16_f32 v177, v174, v175
    v_perm_b32 v172, v176, v4, s3
    v_perm_b32 v173, v176, v4, s99
    v_perm_b32 v174, v177, v4, s3
    v_perm_b32 v175, v177, v4, s99
    buffer_store_dwordx4 v[172:175], v129, s[84:87], s30 offen sc1
    s_lshr_b32 s43, s5, 1
    s_mul_i32 s41, s43, 3
    s_and_b32 s43, s5, 1
    s_lshl_b32 s40, s43, 1
    s_add_u32 s40, s40, s41
    s_add_u32 s41, s41, 1
    v_lshrrev_b32 v27, 2, v1
    v_mul_u32_u24 v27, 192, v27
    v_and_b32 v31, 3, v1
    v_lshl_add_u32 v27, v31, 3, v27
    v_and_b32 v31, 1, v2
    v_xor_b32 v30, s40, v31
    v_lshl_add_u32 v28, v30, 5, v27
    v_add_u32 v29, 24576, v28
    v_xor_b32 v30, s41, v31
    v_lshl_add_u32 v30, v30, 5, v27
    s_mul_i32 s43, s43, 24576
    v_add_u32 v30, s43, v30
    s_waitcnt vmcnt(1)
    s_barrier
    buffer_store_dword v4, v23, s[84:87], s12 offen sc1
    v_lshlrev_b32 v11, 4, v0
    s_mov_b32 s43, 69632
    buffer_load_dwordx4 v[192:195], v11, s[84:87], s43 offen sc1
    s_mov_b32 s43, 73728
    buffer_load_dwordx4 v[196:199], v11, s[84:87], s43 offen sc1
    ds_read_b64_tr_b16 a[0:1], v28 offset:0
    ds_read_b64_tr_b16 a[2:3], v28 offset:3072
    ds_read_b64_tr_b16 a[12:13], v28 offset:6144
    ds_read_b64_tr_b16 a[14:15], v28 offset:9216
    ds_read_b64_tr_b16 a[24:25], v28 offset:12288
    ds_read_b64_tr_b16 a[26:27], v28 offset:15360
    ds_read_b64_tr_b16 a[36:37], v28 offset:18432
    ds_read_b64_tr_b16 a[38:39], v28 offset:21504
    ds_read_b64_tr_b16 a[4:5], v29 offset:0
    ds_read_b64_tr_b16 a[6:7], v29 offset:3072
    ds_read_b64_tr_b16 a[16:17], v29 offset:6144
    ds_read_b64_tr_b16 a[18:19], v29 offset:9216
    ds_read_b64_tr_b16 a[28:29], v29 offset:12288
    ds_read_b64_tr_b16 a[30:31], v29 offset:15360
    ds_read_b64_tr_b16 a[40:41], v29 offset:18432
    ds_read_b64_tr_b16 a[42:43], v29 offset:21504
    ds_read_b64_tr_b16 a[8:9], v30 offset:0
    ds_read_b64_tr_b16 a[10:11], v30 offset:3072
    ds_read_b64_tr_b16 a[20:21], v30 offset:6144
    ds_read_b64_tr_b16 a[22:23], v30 offset:9216
    ds_read_b64_tr_b16 a[32:33], v30 offset:12288
    ds_read_b64_tr_b16 a[34:35], v30 offset:15360
    ds_read_b64_tr_b16 a[44:45], v30 offset:18432
    ds_read_b64_tr_b16 a[46:47], v30 offset:21504
    v_add_u32 v31, 65536, v28
    ds_read_b64_tr_b16 a[48:49], v31 offset:0
    ds_read_b64_tr_b16 a[50:51], v31 offset:3072
    ds_read_b64_tr_b16 a[60:61], v31 offset:6144
    ds_read_b64_tr_b16 a[62:63], v31 offset:9216
    ds_read_b64_tr_b16 a[72:73], v31 offset:12288
    ds_read_b64_tr_b16 a[74:75], v31 offset:15360
    ds_read_b64_tr_b16 a[84:85], v31 offset:18432
    ds_read_b64_tr_b16 a[86:87], v31 offset:21504
    v_add_u32 v31, 65536, v29
    ds_read_b64_tr_b16 a[52:53], v31 offset:0
    ds_read_b64_tr_b16 a[54:55], v31 offset:3072
    ds_read_b64_tr_b16 a[64:65], v31 offset:6144
    ds_read_b64_tr_b16 a[66:67], v31 offset:9216
    ds_read_b64_tr_b16 a[76:77], v31 offset:12288
    ds_read_b64_tr_b16 a[78:79], v31 offset:15360
    ds_read_b64_tr_b16 a[88:89], v31 offset:18432
    ds_read_b64_tr_b16 a[90:91], v31 offset:21504
    v_add_u32 v31, 65536, v30
    ds_read_b64_tr_b16 a[56:57], v31 offset:0
    ds_read_b64_tr_b16 a[58:59], v31 offset:3072
    ds_read_b64_tr_b16 a[68:69], v31 offset:6144
    ds_read_b64_tr_b16 a[70:71], v31 offset:9216
    ds_read_b64_tr_b16 a[80:81], v31 offset:12288
    ds_read_b64_tr_b16 a[82:83], v31 offset:15360
    ds_read_b64_tr_b16 a[92:93], v31 offset:18432
    ds_read_b64_tr_b16 a[94:95], v31 offset:21504
    s_waitcnt lgkmcnt(0)
    s_barrier
    s_add_u32 m0, s42, 0
    s_add_u32 s35, s22, 0
    buffer_load_dwordx4 v24, s[72:75], s35 offen offset:0 lds
    buffer_load_dwordx4 v25, s[72:75], s35 offen offset:1024 lds
    buffer_load_dwordx4 v26, s[72:75], s35 offen offset:2048 lds
    s_add_u32 m0, s42, 3072
    s_add_u32 s35, s22, 44032
    buffer_load_dwordx4 v24, s[72:75], s35 offen offset:0 lds
    buffer_load_dwordx4 v25, s[72:75], s35 offen offset:1024 lds
    buffer_load_dwordx4 v26, s[72:75], s35 offen offset:2048 lds
    s_add_u32 m0, s42, 6144
    s_add_u32 s35, s22, 88064
    buffer_load_dwordx4 v24, s[72:75], s35 offen offset:0 lds
    buffer_load_dwordx4 v25, s[72:75], s35 offen offset:1024 lds
    s_lshl_b32 s12, s5, 3
    s_mul_i32 s30, s12, 2176
    buffer_load_dwordx4 v26, s[72:75], s35 offen offset:2048 lds
    s_add_u32 s30, s30, 131072
    v_and_b32 v14, 3, v3
    s_add_u32 m0, s42, 9216
    s_add_u32 s35, s22, 132096
    v_mul_u32_u24 v14, 2176, v14
    buffer_load_dwordx4 v24, s[72:75], s35 offen offset:0 lds
    v_and_b32 v15, 1, v2
    v_lshl_add_u32 v14, v15, 6, v14
    buffer_load_dwordx4 v25, s[72:75], s35 offen offset:1024 lds
    v_lshrrev_b32 v15, 1, v2
    v_lshl_add_u32 v14, v15, 4, v14
    buffer_load_dwordx4 v26, s[72:75], s35 offen offset:2048 lds
    v_lshlrev_b32 v15, 9, v2
    v_lshl_add_u32 v15, v3, 4, v15
    s_add_u32 m0, s42, 49152
    s_add_u32 s35, s23, 0
    buffer_load_dwordx4 v24, s[72:75], s35 offen offset:0 lds
    s_lshl_b32 s11, s36, 4
    s_lshl_b32 s12, s5, 1
    buffer_load_dwordx4 v25, s[72:75], s35 offen offset:1024 lds
    s_add_u32 s11, s11, s12
    v_and_b32 v20, 1, v1
    buffer_load_dwordx4 v26, s[72:75], s35 offen offset:2048 lds
    v_bfe_u32 v21, v1, 1, 1
    v_lshl_add_u32 v20, v21, 3, v20
    s_add_u32 m0, s42, 52224
    s_add_u32 s35, s23, 44032
    buffer_load_dwordx4 v24, s[72:75], s35 offen offset:0 lds
    v_add_u32 v20, s11, v20
    v_lshlrev_b32 v20, 7, v20
    buffer_load_dwordx4 v25, s[72:75], s35 offen offset:1024 lds
    v_add_u32 v20, 524288, v20
    s_lshr_b32 s11, s37, 3
    s_lshl_b32 s11, s11, 1
    buffer_load_dwordx4 v26, s[72:75], s35 offen offset:2048 lds
    s_and_b32 s13, s5, 1
    s_add_u32 s11, s11, s13
    s_add_u32 m0, s42, 55296
    s_add_u32 s35, s23, 88064
    buffer_load_dwordx4 v24, s[72:75], s35 offen offset:0 lds
    s_mul_i32 s76, s11, 32768
    s_xor_b32 s11, s11, 1
    buffer_load_dwordx4 v25, s[72:75], s35 offen offset:1024 lds
    s_mul_i32 s77, s11, 32768
    s_add_u32 s78, s76, 131072
    buffer_load_dwordx4 v26, s[72:75], s35 offen offset:2048 lds
    s_add_u32 s79, s77, 131072
    s_lshl_b32 s11, s36, 18
    s_add_u32 m0, s42, 58368
    s_add_u32 s35, s23, 132096
    buffer_load_dwordx4 v24, s[72:75], s35 offen offset:0 lds
    s_lshl_b32 s12, s5, 13
    s_add_u32 s11, s11, s12
    buffer_load_dwordx4 v25, s[72:75], s35 offen offset:1024 lds
    s_add_u32 s11, s11, 4194304
    v_add_u32 v22, s11, v5
    buffer_load_dwordx4 v26, s[72:75], s35 offen offset:2048 lds
    v_add_u32 v27, 4096, v22
    buffer_load_dword v21, v20, s[84:87], 0 offen sc1
    s_waitcnt vmcnt(25)
    v_perm_b32 v9, v193, v192, s3
    v_xor_b32 v8, v9, v4
    v_perm_b32 v9, v195, v194, s3
    v_bitop3_b32 v8, v8, v9, v4 bitop3:0xf6
    v_perm_b32 v9, v197, v196, s3
    v_bitop3_b32 v8, v8, v9, v4 bitop3:0xf6
    v_perm_b32 v9, v199, v198, s3
    v_bitop3_b32 v8, v8, v9, v4 bitop3:0xf6
    v_cmp_ne_u32 vcc, 0, v8
    s_cbranch_vccz Ldone_6
    s_mov_b32 s15, 0
    s_nop 3
Lspin_5:
    s_mov_b32 s43, 69632
    buffer_load_dwordx4 v[192:195], v11, s[84:87], s43 offen sc1
    s_mov_b32 s43, 73728
    buffer_load_dwordx4 v[196:199], v11, s[84:87], s43 offen sc1
    s_waitcnt vmcnt(0)
    v_perm_b32 v9, v193, v192, s3
    v_xor_b32 v8, v9, v4
    v_perm_b32 v9, v195, v194, s3
    v_bitop3_b32 v8, v8, v9, v4 bitop3:0xf6
    v_perm_b32 v9, v197, v196, s3
    v_bitop3_b32 v8, v8, v9, v4 bitop3:0xf6
    v_perm_b32 v9, v199, v198, s3
    v_bitop3_b32 v8, v8, v9, v4 bitop3:0xf6
    v_cmp_ne_u32 vcc, 0, v8
    s_cbranch_vccz Ldone_6
    s_add_u32 s15, s15, 1
    s_cmp_lt_u32 s15, 400000
    s_cbranch_scc1 Lspin_5
Ldone_6:
    s_nop 1
    v_add_u32 v6, 147456, v11
    v_and_b32 v192, s98, v192
    v_and_b32 v193, s98, v193
    v_and_b32 v194, s98, v194
    v_and_b32 v195, s98, v195
    ds_write_b128 v6, v[192:195] offset:4096
    v_and_b32 v196, s98, v196
    v_and_b32 v197, s98, v197
    v_and_b32 v198, s98, v198
    v_and_b32 v199, s98, v199
    ds_write_b128 v6, v[196:199] offset:8192
    v_cmp_gt_u32 vcc, 128, v0
    s_nop 1
    v_cndmask_b32 v192, v192, v196, vcc
    v_cndmask_b32 v193, v193, v197, vcc
    v_cndmask_b32 v194, v194, v198, vcc
    v_cndmask_b32 v195, v195, v199, vcc
    v_perm_b32 v196, v193, v192, s99
    v_perm_b32 v197, v195, v194, s99
    v_lshrrev_b32 v6, 3, v0
    v_lshlrev_b32 v6, 6, v6
    v_and_b32 v8, 3, v0
    v_lshl_add_u32 v6, v8, 4, v6
    v_bfe_u32 v8, v0, 2, 1
    v_lshl_add_u32 v6, v8, 3, v6
    v_add_u32 v6, 160768, v6
    ds_write_b64 v6, v[196:197]
    s_add_u32 s11, s30, 0
    buffer_load_dwordx4 v[192:195], v15, s[84:87], s11 offen sc1
    buffer_load_dwordx4 v[196:199], v15, s[84:87], s11 offen offset:256 sc1
    buffer_load_dwordx4 v[32:35], v14, s[84:87], s11 offen offset:2048 sc1
    buffer_load_dwordx4 v[36:39], v14, s[84:87], s11 offen offset:2080 sc1
    s_add_u32 s11, s30, 2176
    buffer_load_dwordx4 v[200:203], v15, s[84:87], s11 offen sc1
    buffer_load_dwordx4 v[204:207], v15, s[84:87], s11 offen offset:256 sc1
    s_add_u32 s11, s30, 4352
    buffer_load_dwordx4 v[208:211], v15, s[84:87], s11 offen sc1
    buffer_load_dwordx4 v[212:215], v15, s[84:87], s11 offen offset:256 sc1
    s_add_u32 s11, s30, 6528
    buffer_load_dwordx4 v[216:219], v15, s[84:87], s11 offen sc1
    buffer_load_dwordx4 v[220:223], v15, s[84:87], s11 offen offset:256 sc1
    s_add_u32 s11, s30, 8704
    buffer_load_dwordx4 v[224:227], v15, s[84:87], s11 offen sc1
    buffer_load_dwordx4 v[228:231], v15, s[84:87], s11 offen offset:256 sc1
    buffer_load_dwordx4 v[40:43], v14, s[84:87], s11 offen offset:2048 sc1
    buffer_load_dwordx4 v[44:47], v14, s[84:87], s11 offen offset:2080 sc1
    s_add_u32 s11, s30, 10880
    buffer_load_dwordx4 v[232:235], v15, s[84:87], s11 offen sc1
    buffer_load_dwordx4 v[236:239], v15, s[84:87], s11 offen offset:256 sc1
    s_add_u32 s11, s30, 13056
    buffer_load_dwordx4 v[240:243], v15, s[84:87], s11 offen sc1
    buffer_load_dwordx4 v[244:247], v15, s[84:87], s11 offen offset:256 sc1
    s_add_u32 s11, s30, 15232
    buffer_load_dwordx4 v[248:251], v15, s[84:87], s11 offen sc1
    buffer_load_dwordx4 v[252:255], v15, s[84:87], s11 offen offset:256 sc1
    s_waitcnt vmcnt(21)
    s_waitcnt lgkmcnt(0)
    s_barrier
    s_waitcnt vmcnt(20)
    v_cmp_ne_u32 vcc, v21, v4
    s_cbranch_vccz Ldone_8
    s_mov_b32 s15, 0
    s_nop 3
Lspin_7:
    buffer_load_dword v21, v20, s[84:87], 0 offen sc1
    s_waitcnt vmcnt(0)
    v_cmp_ne_u32 vcc, v21, v4
    s_cbranch_vccz Ldone_8
    s_add_u32 s15, s15, 1
    s_cmp_lt_u32 s15, 400000
    s_cbranch_scc1 Lspin_7
Ldone_8:
    s_nop 1
    buffer_load_dwordx4 v[64:67], v22, s[84:87], s76 offen offset:0 sc1
    ds_read_b64_tr_b16 a[96:97], v28 offset:0
    ds_read_b64_tr_b16 a[98:99], v28 offset:3072
    ds_read_b64_tr_b16 a[108:109], v28 offset:6144
    ds_read_b64_tr_b16 a[110:111], v28 offset:9216
    buffer_load_dwordx4 v[80:83], v22, s[84:87], s76 offen offset:1024 sc1
    ds_read_b64_tr_b16 a[120:121], v28 offset:12288
    ds_read_b64_tr_b16 a[122:123], v28 offset:15360
    ds_read_b64_tr_b16 a[132:133], v28 offset:18432
    buffer_load_dwordx4 v[68:71], v22, s[84:87], s77 offen offset:0 sc1
    ds_read_b64_tr_b16 a[134:135], v28 offset:21504
    ds_read_b64_tr_b16 a[100:101], v29 offset:0
    ds_read_b64_tr_b16 a[102:103], v29 offset:3072
    buffer_load_dwordx4 v[84:87], v22, s[84:87], s77 offen offset:1024 sc1
    ds_read_b64_tr_b16 a[112:113], v29 offset:6144
    ds_read_b64_tr_b16 a[114:115], v29 offset:9216
    ds_read_b64_tr_b16 a[124:125], v29 offset:12288
    buffer_load_dwordx4 v[96:99], v22, s[84:87], s76 offen offset:2048 sc1
    ds_read_b64_tr_b16 a[126:127], v29 offset:15360
    ds_read_b64_tr_b16 a[136:137], v29 offset:18432
    ds_read_b64_tr_b16 a[138:139], v29 offset:21504
    buffer_load_dwordx4 v[112:115], v22, s[84:87], s76 offen offset:3072 sc1
    ds_read_b64_tr_b16 a[104:105], v30 offset:0
    ds_read_b64_tr_b16 a[106:107], v30 offset:3072
    ds_read_b64_tr_b16 a[116:117], v30 offset:6144
    ds_read_b64_tr_b16 a[118:119], v30 offset:9216
    buffer_load_dwordx4 v[100:103], v22, s[84:87], s77 offen offset:2048 sc1
    ds_read_b64_tr_b16 a[128:129], v30 offset:12288
    ds_read_b64_tr_b16 a[130:131], v30 offset:15360
    ds_read_b64_tr_b16 a[140:141], v30 offset:18432
    buffer_load_dwordx4 v[116:119], v22, s[84:87], s77 offen offset:3072 sc1
    ds_read_b64_tr_b16 a[142:143], v30 offset:21504
    v_add_u32 v31, 49152, v28
    ds_read_b64_tr_b16 a[144:145], v31 offset:0
    buffer_load_dwordx4 v[128:131], v27, s[84:87], s76 offen offset:0 sc1
    ds_read_b64_tr_b16 a[146:147], v31 offset:3072
    ds_read_b64_tr_b16 a[156:157], v31 offset:6144
    ds_read_b64_tr_b16 a[158:159], v31 offset:9216
    buffer_load_dwordx4 v[144:147], v27, s[84:87], s76 offen offset:1024 sc1
    ds_read_b64_tr_b16 a[168:169], v31 offset:12288
    ds_read_b64_tr_b16 a[170:171], v31 offset:15360
    ds_read_b64_tr_b16 a[180:181], v31 offset:18432
    buffer_load_dwordx4 v[132:135], v27, s[84:87], s77 offen offset:0 sc1
    ds_read_b64_tr_b16 a[182:183], v31 offset:21504
    v_add_u32 v31, 49152, v29
    ds_read_b64_tr_b16 a[148:149], v31 offset:0
    ds_read_b64_tr_b16 a[150:151], v31 offset:3072
    buffer_load_dwordx4 v[148:151], v27, s[84:87], s77 offen offset:1024 sc1
    ds_read_b64_tr_b16 a[160:161], v31 offset:6144
    ds_read_b64_tr_b16 a[162:163], v31 offset:9216
    ds_read_b64_tr_b16 a[172:173], v31 offset:12288
    buffer_load_dwordx4 v[160:163], v27, s[84:87], s76 offen offset:2048 sc1
    ds_read_b64_tr_b16 a[174:175], v31 offset:15360
    ds_read_b64_tr_b16 a[184:185], v31 offset:18432
    ds_read_b64_tr_b16 a[186:187], v31 offset:21504
    buffer_load_dwordx4 v[176:179], v27, s[84:87], s76 offen offset:3072 sc1
    v_add_u32 v31, 49152, v30
    ds_read_b64_tr_b16 a[152:153], v31 offset:0
    ds_read_b64_tr_b16 a[154:155], v31 offset:3072
    buffer_load_dwordx4 v[164:167], v27, s[84:87], s77 offen offset:2048 sc1
    ds_read_b64_tr_b16 a[164:165], v31 offset:6144
    ds_read_b64_tr_b16 a[166:167], v31 offset:9216
    ds_read_b64_tr_b16 a[176:177], v31 offset:12288
    buffer_load_dwordx4 v[180:183], v27, s[84:87], s77 offen offset:3072 sc1
    ds_read_b64_tr_b16 a[178:179], v31 offset:15360
    ds_read_b64_tr_b16 a[188:189], v31 offset:18432
    ds_read_b64_tr_b16 a[190:191], v31 offset:21504
    s_waitcnt vmcnt(16)
    v_perm_b32 v17, v193, v192, s3
    v_xor_b32 v16, v17, v4
    v_perm_b32 v18, v197, v196, s3
    v_bitop3_b32 v16, v16, v18, v4 bitop3:0xf6
    v_perm_b32 v17, v201, v200, s3
    v_bitop3_b32 v16, v16, v17, v4 bitop3:0xf6
    v_perm_b32 v18, v205, v204, s3
    v_bitop3_b32 v16, v16, v18, v4 bitop3:0xf6
    v_perm_b32 v17, v209, v208, s3
    v_bitop3_b32 v16, v16, v17, v4 bitop3:0xf6
    v_perm_b32 v18, v213, v212, s3
    v_bitop3_b32 v16, v16, v18, v4 bitop3:0xf6
    v_perm_b32 v17, v217, v216, s3
    v_bitop3_b32 v16, v16, v17, v4 bitop3:0xf6
    v_perm_b32 v18, v221, v220, s3
    v_bitop3_b32 v16, v16, v18, v4 bitop3:0xf6
    v_perm_b32 v17, v225, v224, s3
    v_bitop3_b32 v16, v16, v17, v4 bitop3:0xf6
    v_perm_b32 v18, v229, v228, s3
    v_bitop3_b32 v16, v16, v18, v4 bitop3:0xf6
    v_perm_b32 v17, v233, v232, s3
    v_bitop3_b32 v16, v16, v17, v4 bitop3:0xf6
    v_perm_b32 v18, v237, v236, s3
    v_bitop3_b32 v16, v16, v18, v4 bitop3:0xf6
    v_perm_b32 v17, v241, v240, s3
    v_bitop3_b32 v16, v16, v17, v4 bitop3:0xf6
    v_perm_b32 v18, v245, v244, s3
    v_bitop3_b32 v16, v16, v18, v4 bitop3:0xf6
    v_perm_b32 v17, v249, v248, s3
    v_bitop3_b32 v16, v16, v17, v4 bitop3:0xf6
    v_perm_b32 v18, v253, v252, s3
    v_bitop3_b32 v16, v16, v18, v4 bitop3:0xf6
    v_perm_b32 v17, v33, v32, s3
    v_bitop3_b32 v16, v16, v17, v4 bitop3:0xf6
    v_perm_b32 v18, v37, v36, s3
    v_bitop3_b32 v16, v16, v18, v4 bitop3:0xf6
    v_perm_b32 v17, v41, v40, s3
    v_bitop3_b32 v16, v16, v17, v4 bitop3:0xf6
    v_perm_b32 v18, v45, v44, s3
    v_bitop3_b32 v16, v16, v18, v4 bitop3:0xf6
    v_cmp_ne_u32 vcc, 0, v16
    s_cbranch_vccz Ldone_10
    s_mov_b32 s15, 0
    s_nop 3
Lspin_9:
    s_add_u32 s11, s30, 0
    buffer_load_dwordx4 v[192:195], v15, s[84:87], s11 offen sc1
    buffer_load_dwordx4 v[196:199], v15, s[84:87], s11 offen offset:256 sc1
    buffer_load_dwordx4 v[32:35], v14, s[84:87], s11 offen offset:2048 sc1
    buffer_load_dwordx4 v[36:39], v14, s[84:87], s11 offen offset:2080 sc1
    s_add_u32 s11, s30, 2176
    buffer_load_dwordx4 v[200:203], v15, s[84:87], s11 offen sc1
    buffer_load_dwordx4 v[204:207], v15, s[84:87], s11 offen offset:256 sc1
    s_add_u32 s11, s30, 4352
    buffer_load_dwordx4 v[208:211], v15, s[84:87], s11 offen sc1
    buffer_load_dwordx4 v[212:215], v15, s[84:87], s11 offen offset:256 sc1
    s_add_u32 s11, s30, 6528
    buffer_load_dwordx4 v[216:219], v15, s[84:87], s11 offen sc1
    buffer_load_dwordx4 v[220:223], v15, s[84:87], s11 offen offset:256 sc1
    s_add_u32 s11, s30, 8704
    buffer_load_dwordx4 v[224:227], v15, s[84:87], s11 offen sc1
    buffer_load_dwordx4 v[228:231], v15, s[84:87], s11 offen offset:256 sc1
    buffer_load_dwordx4 v[40:43], v14, s[84:87], s11 offen offset:2048 sc1
    buffer_load_dwordx4 v[44:47], v14, s[84:87], s11 offen offset:2080 sc1
    s_add_u32 s11, s30, 10880
    buffer_load_dwordx4 v[232:235], v15, s[84:87], s11 offen sc1
    buffer_load_dwordx4 v[236:239], v15, s[84:87], s11 offen offset:256 sc1
    s_add_u32 s11, s30, 13056
    buffer_load_dwordx4 v[240:243], v15, s[84:87], s11 offen sc1
    buffer_load_dwordx4 v[244:247], v15, s[84:87], s11 offen offset:256 sc1
    s_add_u32 s11, s30, 15232
    buffer_load_dwordx4 v[248:251], v15, s[84:87], s11 offen sc1
    buffer_load_dwordx4 v[252:255], v15, s[84:87], s11 offen offset:256 sc1
    s_waitcnt vmcnt(0)
    v_perm_b32 v17, v193, v192, s3
    v_xor_b32 v16, v17, v4
    v_perm_b32 v18, v197, v196, s3
    v_bitop3_b32 v16, v16, v18, v4 bitop3:0xf6
    v_perm_b32 v17, v201, v200, s3
    v_bitop3_b32 v16, v16, v17, v4 bitop3:0xf6
    v_perm_b32 v18, v205, v204, s3
    v_bitop3_b32 v16, v16, v18, v4 bitop3:0xf6
    v_perm_b32 v17, v209, v208, s3
    v_bitop3_b32 v16, v16, v17, v4 bitop3:0xf6
    v_perm_b32 v18, v213, v212, s3
    v_bitop3_b32 v16, v16, v18, v4 bitop3:0xf6
    v_perm_b32 v17, v217, v216, s3
    v_bitop3_b32 v16, v16, v17, v4 bitop3:0xf6
    v_perm_b32 v18, v221, v220, s3
    v_bitop3_b32 v16, v16, v18, v4 bitop3:0xf6
    v_perm_b32 v17, v225, v224, s3
    v_bitop3_b32 v16, v16, v17, v4 bitop3:0xf6
    v_perm_b32 v18, v229, v228, s3
    v_bitop3_b32 v16, v16, v18, v4 bitop3:0xf6
    v_perm_b32 v17, v233, v232, s3
    v_bitop3_b32 v16, v16, v17, v4 bitop3:0xf6
    v_perm_b32 v18, v237, v236, s3
    v_bitop3_b32 v16, v16, v18, v4 bitop3:0xf6
    v_perm_b32 v17, v241, v240, s3
    v_bitop3_b32 v16, v16, v17, v4 bitop3:0xf6
    v_perm_b32 v18, v245, v244, s3
    v_bitop3_b32 v16, v16, v18, v4 bitop3:0xf6
    v_perm_b32 v17, v249, v248, s3
    v_bitop3_b32 v16, v16, v17, v4 bitop3:0xf6
    v_perm_b32 v18, v253, v252, s3
    v_bitop3_b32 v16, v16, v18, v4 bitop3:0xf6
    v_perm_b32 v17, v33, v32, s3
    v_bitop3_b32 v16, v16, v17, v4 bitop3:0xf6
    v_perm_b32 v18, v37, v36, s3
    v_bitop3_b32 v16, v16, v18, v4 bitop3:0xf6
    v_perm_b32 v17, v41, v40, s3
    v_bitop3_b32 v16, v16, v17, v4 bitop3:0xf6
    v_perm_b32 v18, v45, v44, s3
    v_bitop3_b32 v16, v16, v18, v4 bitop3:0xf6
    v_cmp_ne_u32 vcc, 0, v16
    s_cbranch_vccz Ldone_10
    s_add_u32 s15, s15, 1
    s_cmp_lt_u32 s15, 400000
    s_cbranch_scc1 Lspin_9
Ldone_10:
    s_nop 1
    v_perm_b32 v8, v33, v32, s99
    v_perm_b32 v9, v35, v34, s99
    v_perm_b32 v10, v37, v36, s99
    v_perm_b32 v11, v39, v38, s99
    v_perm_b32 v12, v41, v40, s99
    v_perm_b32 v13, v43, v42, s99
    v_perm_b32 v14, v45, v44, s99
    v_perm_b32 v15, v47, v46, s99
    v_perm_b32 v32, v193, v192, s99
    v_perm_b32 v33, v195, v194, s99
    v_perm_b32 v34, v197, v196, s99
    v_perm_b32 v35, v199, v198, s99
    v_perm_b32 v36, v201, v200, s99
    v_perm_b32 v37, v203, v202, s99
    v_perm_b32 v38, v205, v204, s99
    v_perm_b32 v39, v207, v206, s99
    v_perm_b32 v40, v209, v208, s99
    v_perm_b32 v41, v211, v210, s99
    v_perm_b32 v42, v213, v212, s99
    v_perm_b32 v43, v215, v214, s99
    v_perm_b32 v44, v217, v216, s99
    v_perm_b32 v45, v219, v218, s99
    v_perm_b32 v46, v221, v220, s99
    v_perm_b32 v47, v223, v222, s99
    v_perm_b32 v48, v225, v224, s99
    v_perm_b32 v49, v227, v226, s99
    v_perm_b32 v50, v229, v228, s99
    v_perm_b32 v51, v231, v230, s99
    v_perm_b32 v52, v233, v232, s99
    v_perm_b32 v53, v235, v234, s99
    v_perm_b32 v54, v237, v236, s99
    v_perm_b32 v55, v239, v238, s99
    v_perm_b32 v56, v241, v240, s99
    v_perm_b32 v57, v243, v242, s99
    v_perm_b32 v58, v245, v244, s99
    v_perm_b32 v59, v247, v246, s99
    v_perm_b32 v60, v249, v248, s99
    v_perm_b32 v61, v251, v250, s99
    v_perm_b32 v62, v253, v252, s99
    v_perm_b32 v63, v255, v254, s99
    v_mov_b32 v16, 0x358637bd
    v_mov_b32 v17, 0x358637bd
    v_mov_b32 v18, 0x358637bd
    v_mov_b32 v19, 0x358637bd
    s_waitcnt vmcnt(14)
    s_nop 0
    v_mfma_f32_16x16x32_bf16 v[216:219], v[8:11], v[64:67], v[16:19]
    v_mfma_f32_16x16x32_bf16 v[248:251], v[8:11], v[80:83], v[16:19]
    v_mfma_f32_16x16x32_bf16 v[200:203], v[32:35], v[64:67], 0
    v_mfma_f32_16x16x32_bf16 v[232:235], v[36:39], v[80:83], 0
    buffer_load_dwordx4 v[72:75], v22, s[84:87], s78 offen offset:0 sc1
    buffer_load_dwordx4 v[88:91], v22, s[84:87], s78 offen offset:1024 sc1
    buffer_load_dwordx4 v[76:79], v22, s[84:87], s79 offen offset:0 sc1
    buffer_load_dwordx4 v[92:95], v22, s[84:87], s79 offen offset:1024 sc1
    s_waitcnt vmcnt(16)
    v_mfma_f32_16x16x32_bf16 v[220:223], v[8:11], v[68:71], v[16:19]
    v_rcp_f32 v6, v216
    v_rcp_f32 v7, v249
    v_mfma_f32_16x16x32_bf16 v[252:255], v[8:11], v[84:87], v[16:19]
    v_mul_f32 v200, v200, v6
    v_mul_f32 v201, v201, v6
    v_mfma_f32_16x16x32_bf16 v[204:207], v[32:35], v[68:71], 0
    v_mul_f32 v202, v202, v6
    v_mul_f32 v203, v203, v6
    v_mfma_f32_16x16x32_bf16 v[236:239], v[36:39], v[84:87], 0
    v_cvt_pk_bf16_f32 v64, v200, v201
    v_cvt_pk_bf16_f32 v65, v202, v203
    v_mul_f32 v232, v232, v7
    v_mul_f32 v233, v233, v7
    v_mul_f32 v234, v234, v7
    v_mul_f32 v235, v235, v7
    v_cvt_pk_bf16_f32 v66, v232, v233
    v_cvt_pk_bf16_f32 v67, v234, v235
    buffer_load_dwordx4 v[104:107], v22, s[84:87], s78 offen offset:2048 sc1
    buffer_load_dwordx4 v[120:123], v22, s[84:87], s78 offen offset:3072 sc1
    buffer_load_dwordx4 v[108:111], v22, s[84:87], s79 offen offset:2048 sc1
    buffer_load_dwordx4 v[124:127], v22, s[84:87], s79 offen offset:3072 sc1
    s_waitcnt vmcnt(18)
    v_mfma_f32_16x16x32_bf16 v[192:195], a[192:195], v[64:67], 0
    v_rcp_f32 v6, v220
    v_rcp_f32 v7, v253
    v_mfma_f32_16x16x32_bf16 v[208:211], a[196:199], v[64:67], 0
    v_mul_f32 v204, v204, v6
    v_mul_f32 v205, v205, v6
    v_mfma_f32_16x16x32_bf16 v[224:227], a[200:203], v[64:67], 0
    v_mul_f32 v206, v206, v6
    v_mul_f32 v207, v207, v6
    v_mfma_f32_16x16x32_bf16 v[240:243], a[204:207], v[64:67], 0
    v_cvt_pk_bf16_f32 v68, v204, v205
    v_cvt_pk_bf16_f32 v69, v206, v207
    v_mfma_f32_16x16x32_bf16 v[216:219], v[8:11], v[96:99], v[16:19]
    v_mul_f32 v236, v236, v7
    v_mul_f32 v237, v237, v7
    v_mfma_f32_16x16x32_bf16 v[248:251], v[8:11], v[112:115], v[16:19]
    v_mul_f32 v238, v238, v7
    v_mul_f32 v239, v239, v7
    v_mfma_f32_16x16x32_bf16 v[200:203], v[40:43], v[96:99], 0
    v_cvt_pk_bf16_f32 v70, v236, v237
    v_cvt_pk_bf16_f32 v71, v238, v239
    v_mfma_f32_16x16x32_bf16 v[232:235], v[44:47], v[112:115], 0
    buffer_load_dwordx4 v[136:139], v27, s[84:87], s78 offen offset:0 sc1
    buffer_load_dwordx4 v[152:155], v27, s[84:87], s78 offen offset:1024 sc1
    buffer_load_dwordx4 v[140:143], v27, s[84:87], s79 offen offset:0 sc1
    buffer_load_dwordx4 v[156:159], v27, s[84:87], s79 offen offset:1024 sc1
    s_waitcnt vmcnt(20)
    v_mfma_f32_16x16x32_bf16 v[196:199], a[192:195], v[68:71], 0
    v_rcp_f32 v6, v218
    v_rcp_f32 v7, v251
    v_mfma_f32_16x16x32_bf16 v[212:215], a[196:199], v[68:71], 0
    v_mul_f32 v200, v200, v6
    v_mul_f32 v201, v201, v6
    v_mfma_f32_16x16x32_bf16 v[228:231], a[200:203], v[68:71], 0
    v_mul_f32 v202, v202, v6
    v_mul_f32 v203, v203, v6
    v_mfma_f32_16x16x32_bf16 v[244:247], a[204:207], v[68:71], 0
    v_cvt_pk_bf16_f32 v96, v200, v201
    v_cvt_pk_bf16_f32 v97, v202, v203
    v_mfma_f32_16x16x32_bf16 v[220:223], v[8:11], v[100:103], v[16:19]
    v_mul_f32 v232, v232, v7
    v_mul_f32 v233, v233, v7
    v_mfma_f32_16x16x32_bf16 v[252:255], v[8:11], v[116:119], v[16:19]
    v_mul_f32 v234, v234, v7
    v_mul_f32 v235, v235, v7
    v_mfma_f32_16x16x32_bf16 v[204:207], v[40:43], v[100:103], 0
    v_cvt_pk_bf16_f32 v98, v232, v233
    v_cvt_pk_bf16_f32 v99, v234, v235
    v_mfma_f32_16x16x32_bf16 v[236:239], v[44:47], v[116:119], 0
    buffer_load_dwordx4 v[168:171], v27, s[84:87], s78 offen offset:2048 sc1
    buffer_load_dwordx4 v[184:187], v27, s[84:87], s78 offen offset:3072 sc1
    buffer_load_dwordx4 v[172:175], v27, s[84:87], s79 offen offset:2048 sc1
    buffer_load_dwordx4 v[188:191], v27, s[84:87], s79 offen offset:3072 sc1
    s_waitcnt vmcnt(22)
    v_mfma_f32_16x16x32_bf16 v[192:195], a[208:211], v[96:99], v[192:195]
    v_rcp_f32 v6, v222
    v_rcp_f32 v7, v255
    v_mfma_f32_16x16x32_bf16 v[208:211], a[212:215], v[96:99], v[208:211]
    v_mul_f32 v204, v204, v6
    v_mul_f32 v205, v205, v6
    v_mfma_f32_16x16x32_bf16 v[224:227], a[216:219], v[96:99], v[224:227]
    v_mul_f32 v206, v206, v6
    v_mul_f32 v207, v207, v6
    v_mfma_f32_16x16x32_bf16 v[240:243], a[220:223], v[96:99], v[240:243]
    v_cvt_pk_bf16_f32 v100, v204, v205
    v_cvt_pk_bf16_f32 v101, v206, v207
    v_mfma_f32_16x16x32_bf16 v[216:219], v[12:15], v[128:131], v[16:19]
    v_mul_f32 v236, v236, v7
    v_mul_f32 v237, v237, v7
    v_mfma_f32_16x16x32_bf16 v[248:251], v[12:15], v[144:147], v[16:19]
    v_mul_f32 v238, v238, v7
    v_mul_f32 v239, v239, v7
    v_mfma_f32_16x16x32_bf16 v[200:203], v[48:51], v[128:131], 0
    v_cvt_pk_bf16_f32 v102, v236, v237
    v_cvt_pk_bf16_f32 v103, v238, v239
    v_mfma_f32_16x16x32_bf16 v[232:235], v[52:55], v[144:147], 0
    s_waitcnt vmcnt(20)
    v_mfma_f32_16x16x32_bf16 v[196:199], a[208:211], v[100:103], v[196:199]
    v_rcp_f32 v6, v216
    v_rcp_f32 v7, v249
    v_mfma_f32_16x16x32_bf16 v[212:215], a[212:215], v[100:103], v[212:215]
    v_mul_f32 v200, v200, v6
    v_mul_f32 v201, v201, v6
    v_mfma_f32_16x16x32_bf16 v[228:231], a[216:219], v[100:103], v[228:231]
    v_mul_f32 v202, v202, v6
    v_mul_f32 v203, v203, v6
    v_mfma_f32_16x16x32_bf16 v[244:247], a[220:223], v[100:103], v[244:247]
    v_cvt_pk_bf16_f32 v128, v200, v201
    v_cvt_pk_bf16_f32 v129, v202, v203
    v_mfma_f32_16x16x32_bf16 v[220:223], v[12:15], v[132:135], v[16:19]
    v_mul_f32 v232, v232, v7
    v_mul_f32 v233, v233, v7
    v_mfma_f32_16x16x32_bf16 v[252:255], v[12:15], v[148:151], v[16:19]
    v_mul_f32 v234, v234, v7
    v_mul_f32 v235, v235, v7
    v_mfma_f32_16x16x32_bf16 v[204:207], v[48:51], v[132:135], 0
    v_cvt_pk_bf16_f32 v130, v232, v233
    v_cvt_pk_bf16_f32 v131, v234, v235
    v_mfma_f32_16x16x32_bf16 v[236:239], v[52:55], v[148:151], 0
    s_lshr_b32 s11, s37, 3
    s_lshl_b32 s11, s11, 1
    s_and_b32 s12, s5, 1
    s_add_u32 s11, s11, s12
    s_lshl_b32 s12, s36, 3
    s_add_u32 s31, s11, s12
    s_lshl_b32 s11, s31, 4
    v_add_u32 v20, s11, v3
    v_lshlrev_b32 v21, 10, v20
    v_lshl_add_u32 v21, v2, 3, v21
    s_lshl_b32 s11, s9, 1
    s_lshr_b32 s12, s5, 1
    s_add_u32 s32, s11, s12
    s_lshl_b32 s11, s32, 6
    s_add_u32 s12, s11, 65536
    buffer_load_dwordx2 v[24:25], v21, s[44:47], s11 offen offset:0
    buffer_load_dwordx2 v[26:27], v21, s[44:47], s11 offen offset:32
    buffer_load_dwordx2 v[28:29], v21, s[44:47], s12 offen offset:0
    buffer_load_dwordx2 v[30:31], v21, s[44:47], s12 offen offset:32
    s_lshl_b32 s11, s32, 7
    s_add_u32 s11, s11, 147456
    v_lshlrev_b32 v22, 4, v2
    v_add_u32 v22, s11, v22
    s_waitcnt vmcnt(22)
    v_mfma_f32_16x16x32_bf16 v[192:195], a[224:227], v[128:131], v[192:195]
    v_rcp_f32 v6, v220
    v_rcp_f32 v7, v253
    v_mfma_f32_16x16x32_bf16 v[208:211], a[228:231], v[128:131], v[208:211]
    v_mul_f32 v204, v204, v6
    v_mul_f32 v205, v205, v6
    v_mfma_f32_16x16x32_bf16 v[224:227], a[232:235], v[128:131], v[224:227]
    v_mul_f32 v206, v206, v6
    v_mul_f32 v207, v207, v6
    v_mfma_f32_16x16x32_bf16 v[240:243], a[236:239], v[128:131], v[240:243]
    v_cvt_pk_bf16_f32 v132, v204, v205
    v_cvt_pk_bf16_f32 v133, v206, v207
    v_mfma_f32_16x16x32_bf16 v[216:219], v[12:15], v[160:163], v[16:19]
    v_mul_f32 v236, v236, v7
    v_mul_f32 v237, v237, v7
    v_mfma_f32_16x16x32_bf16 v[248:251], v[12:15], v[176:179], v[16:19]
    v_mul_f32 v238, v238, v7
    v_mul_f32 v239, v239, v7
    v_mfma_f32_16x16x32_bf16 v[200:203], v[56:59], v[160:163], 0
    v_cvt_pk_bf16_f32 v134, v236, v237
    v_cvt_pk_bf16_f32 v135, v238, v239
    v_mfma_f32_16x16x32_bf16 v[232:235], v[60:63], v[176:179], 0
    s_waitcnt vmcnt(20)
    v_mfma_f32_16x16x32_bf16 v[196:199], a[224:227], v[132:135], v[196:199]
    v_rcp_f32 v6, v218
    v_rcp_f32 v7, v251
    v_mfma_f32_16x16x32_bf16 v[212:215], a[228:231], v[132:135], v[212:215]
    v_mul_f32 v200, v200, v6
    v_mul_f32 v201, v201, v6
    v_mfma_f32_16x16x32_bf16 v[228:231], a[232:235], v[132:135], v[228:231]
    v_mul_f32 v202, v202, v6
    v_mul_f32 v203, v203, v6
    v_mfma_f32_16x16x32_bf16 v[244:247], a[236:239], v[132:135], v[244:247]
    v_cvt_pk_bf16_f32 v160, v200, v201
    v_cvt_pk_bf16_f32 v161, v202, v203
    v_mfma_f32_16x16x32_bf16 v[220:223], v[12:15], v[164:167], v[16:19]
    v_mul_f32 v232, v232, v7
    v_mul_f32 v233, v233, v7
    v_mfma_f32_16x16x32_bf16 v[252:255], v[12:15], v[180:183], v[16:19]
    v_mul_f32 v234, v234, v7
    v_mul_f32 v235, v235, v7
    v_mfma_f32_16x16x32_bf16 v[204:207], v[56:59], v[164:167], 0
    v_cvt_pk_bf16_f32 v162, v232, v233
    v_cvt_pk_bf16_f32 v163, v234, v235
    v_mfma_f32_16x16x32_bf16 v[236:239], v[60:63], v[180:183], 0
    s_waitcnt vmcnt(18)
    v_mfma_f32_16x16x32_bf16 v[192:195], a[240:243], v[160:163], v[192:195]
    v_rcp_f32 v6, v222
    v_rcp_f32 v7, v255
    v_mfma_f32_16x16x32_bf16 v[208:211], a[244:247], v[160:163], v[208:211]
    v_mul_f32 v204, v204, v6
    v_mul_f32 v205, v205, v6
    v_mfma_f32_16x16x32_bf16 v[224:227], a[248:251], v[160:163], v[224:227]
    v_mul_f32 v206, v206, v6
    v_mul_f32 v207, v207, v6
    v_mfma_f32_16x16x32_bf16 v[240:243], a[252:255], v[160:163], v[240:243]
    v_cvt_pk_bf16_f32 v164, v204, v205
    v_cvt_pk_bf16_f32 v165, v206, v207
    v_mfma_f32_16x16x32_bf16 v[80:83], v[8:11], v[72:75], v[16:19]
    v_mul_f32 v236, v236, v7
    v_mul_f32 v237, v237, v7
    v_mfma_f32_16x16x32_bf16 v[84:87], v[8:11], v[88:91], v[16:19]
    v_mul_f32 v238, v238, v7
    v_mul_f32 v239, v239, v7
    v_mfma_f32_16x16x32_bf16 v[64:67], v[32:35], v[72:75], 0
    v_cvt_pk_bf16_f32 v166, v236, v237
    v_cvt_pk_bf16_f32 v167, v238, v239
    v_mfma_f32_16x16x32_bf16 v[68:71], v[36:39], v[88:91], 0
    s_waitcnt vmcnt(16)
    v_mfma_f32_16x16x32_bf16 v[196:199], a[240:243], v[164:167], v[196:199]
    v_rcp_f32 v6, v80
    v_rcp_f32 v7, v85
    v_mfma_f32_16x16x32_bf16 v[212:215], a[244:247], v[164:167], v[212:215]
    v_mul_f32 v64, v64, v6
    v_mul_f32 v65, v65, v6
    v_mfma_f32_16x16x32_bf16 v[228:231], a[248:251], v[164:167], v[228:231]
    v_mul_f32 v66, v66, v6
    v_mul_f32 v67, v67, v6
    v_mfma_f32_16x16x32_bf16 v[244:247], a[252:255], v[164:167], v[244:247]
    v_cvt_pk_bf16_f32 v72, v64, v65
    v_cvt_pk_bf16_f32 v73, v66, v67
    v_mfma_f32_16x16x32_bf16 v[112:115], v[8:11], v[76:79], v[16:19]
    v_mul_f32 v68, v68, v7
    v_mul_f32 v69, v69, v7
    v_mfma_f32_16x16x32_bf16 v[116:119], v[8:11], v[92:95], v[16:19]
    v_mul_f32 v70, v70, v7
    v_mul_f32 v71, v71, v7
    v_mfma_f32_16x16x32_bf16 v[96:99], v[32:35], v[76:79], 0
    v_cvt_pk_bf16_f32 v74, v68, v69
    v_cvt_pk_bf16_f32 v75, v70, v71
    v_mfma_f32_16x16x32_bf16 v[100:103], v[36:39], v[92:95], 0
    s_xor_b32 s11, s5, 1
    s_mul_i32 s11, s11, 6144
    s_add_u32 s11, s11, 98304
    v_add_u32 v6, s11, v5
    ds_write_b128 v6, v[196:199] offset:0
    ds_write_b128 v6, v[212:215] offset:1024
    s_xor_b32 s11, s5, 2
    s_mul_i32 s11, s11, 6144
    s_add_u32 s11, s11, 100352
    v_add_u32 v6, s11, v5
    ds_write_b128 v6, v[224:227] offset:0
    ds_write_b128 v6, v[240:243] offset:1024
    s_xor_b32 s11, s5, 3
    s_mul_i32 s11, s11, 6144
    s_add_u32 s11, s11, 102400
    v_add_u32 v6, s11, v5
    ds_write_b128 v6, v[228:231] offset:0
    ds_write_b128 v6, v[244:247] offset:1024
    s_waitcnt vmcnt(14)
    v_mfma_f32_16x16x32_bf16 v[200:203], a[192:195], v[72:75], 0
    v_rcp_f32 v6, v112
    v_rcp_f32 v7, v117
    v_mfma_f32_16x16x32_bf16 v[216:219], a[196:199], v[72:75], 0
    v_mul_f32 v96, v96, v6
    v_mul_f32 v97, v97, v6
    v_mfma_f32_16x16x32_bf16 v[232:235], a[200:203], v[72:75], 0
    v_mul_f32 v98, v98, v6
    v_mul_f32 v99, v99, v6
    v_mfma_f32_16x16x32_bf16 v[248:251], a[204:207], v[72:75], 0
    v_cvt_pk_bf16_f32 v76, v96, v97
    v_cvt_pk_bf16_f32 v77, v98, v99
    v_mfma_f32_16x16x32_bf16 v[80:83], v[8:11], v[104:107], v[16:19]
    v_mul_f32 v100, v100, v7
    v_mul_f32 v101, v101, v7
    v_mfma_f32_16x16x32_bf16 v[84:87], v[8:11], v[120:123], v[16:19]
    v_mul_f32 v102, v102, v7
    v_mul_f32 v103, v103, v7
    v_mfma_f32_16x16x32_bf16 v[64:67], v[40:43], v[104:107], 0
    v_cvt_pk_bf16_f32 v78, v100, v101
    v_cvt_pk_bf16_f32 v79, v102, v103
    v_mfma_f32_16x16x32_bf16 v[68:71], v[44:47], v[120:123], 0
    s_waitcnt lgkmcnt(0)
    s_barrier
    s_mul_i32 s11, s5, 6144
    s_add_u32 s11, s11, 98304
    v_add_u32 v6, s11, v5
    ds_read_b128 v[196:199], v6 offset:0
    ds_read_b128 v[212:215], v6 offset:1024
    ds_read_b128 v[224:227], v6 offset:2048
    ds_read_b128 v[240:243], v6 offset:3072
    ds_read_b128 v[228:231], v6 offset:4096
    ds_read_b128 v[244:247], v6 offset:5120
    ds_read_b128 v[144:147], v22 offset:4096
    ds_read_b128 v[160:163], v22 offset:8192
    ds_read_b128 v[148:151], v22 offset:4160
    ds_read_b128 v[164:167], v22 offset:8256
    s_waitcnt vmcnt(12)
    v_mfma_f32_16x16x32_bf16 v[204:207], a[192:195], v[76:79], 0
    v_rcp_f32 v6, v82
    v_rcp_f32 v7, v87
    v_mfma_f32_16x16x32_bf16 v[220:223], a[196:199], v[76:79], 0
    v_mul_f32 v64, v64, v6
    v_mul_f32 v65, v65, v6
    v_mfma_f32_16x16x32_bf16 v[236:239], a[200:203], v[76:79], 0
    v_mul_f32 v66, v66, v6
    v_mul_f32 v67, v67, v6
    v_mfma_f32_16x16x32_bf16 v[252:255], a[204:207], v[76:79], 0
    v_cvt_pk_bf16_f32 v104, v64, v65
    v_cvt_pk_bf16_f32 v105, v66, v67
    v_mfma_f32_16x16x32_bf16 v[112:115], v[8:11], v[108:111], v[16:19]
    v_mul_f32 v68, v68, v7
    v_mul_f32 v69, v69, v7
    v_mfma_f32_16x16x32_bf16 v[116:119], v[8:11], v[124:127], v[16:19]
    v_mul_f32 v70, v70, v7
    v_mul_f32 v71, v71, v7
    v_mfma_f32_16x16x32_bf16 v[96:99], v[40:43], v[108:111], 0
    v_cvt_pk_bf16_f32 v106, v68, v69
    v_cvt_pk_bf16_f32 v107, v70, v71
    v_mfma_f32_16x16x32_bf16 v[100:103], v[44:47], v[124:127], 0
    s_waitcnt vmcnt(0)
    v_lshlrev_b32 v176, 16, v24
    v_and_b32 v177, s98, v24
    v_lshlrev_b32 v178, 16, v25
    v_and_b32 v179, s98, v25
    v_lshlrev_b32 v180, 16, v26
    v_and_b32 v181, s98, v26
    v_lshlrev_b32 v182, 16, v27
    v_and_b32 v183, s98, v27
    s_waitcnt lgkmcnt(0)
    v_pk_add_f32 v[128:129], v[192:193], v[196:197]
    v_pk_add_f32 v[224:225], v[224:225], v[228:229]
    v_pk_add_f32 v[130:131], v[194:195], v[198:199]
    v_pk_add_f32 v[226:227], v[226:227], v[230:231]
    v_pk_add_f32 v[132:133], v[208:209], v[212:213]
    v_pk_add_f32 v[240:241], v[240:241], v[244:245]
    v_pk_add_f32 v[134:135], v[210:211], v[214:215]
    v_pk_add_f32 v[242:243], v[242:243], v[246:247]
    v_pk_add_f32 v[128:129], v[128:129], v[224:225]
    v_pk_add_f32 v[130:131], v[130:131], v[226:227]
    v_pk_add_f32 v[132:133], v[132:133], v[240:241]
    v_pk_add_f32 v[134:135], v[134:135], v[242:243]
    v_pk_fma_f32 v[128:129], v[128:129], v[144:145], v[176:177]
    v_pk_fma_f32 v[130:131], v[130:131], v[146:147], v[178:179]
    v_pk_fma_f32 v[132:133], v[132:133], v[148:149], v[180:181]
    v_pk_fma_f32 v[134:135], v[134:135], v[150:151], v[182:183]
    v_cvt_pk_bf16_f32 v24, v128, v129
    v_cvt_pk_bf16_f32 v25, v130, v131
    v_cvt_pk_bf16_f32 v26, v132, v133
    v_cvt_pk_bf16_f32 v27, v134, v135
    s_lshl_b32 s11, s31, 14
    s_lshl_b32 s12, s32, 10
    v_lshlrev_b32 v128, 16, v24
    v_and_b32 v129, s98, v24
    v_lshlrev_b32 v130, 16, v25
    v_and_b32 v131, s98, v25
    v_lshlrev_b32 v132, 16, v26
    v_and_b32 v133, s98, v26
    v_lshlrev_b32 v134, 16, v27
    v_and_b32 v135, s98, v27
    s_add_u32 s11, s11, s12
    s_add_u32 s11, s11, 8388608
    v_pk_mul_f32 v[176:177], v[128:129], v[160:161]
    v_pk_mul_f32 v[178:179], v[130:131], v[162:163]
    v_pk_mul_f32 v[180:181], v[132:133], v[164:165]
    v_pk_mul_f32 v[182:183], v[134:135], v[166:167]
    v_cvt_pk_bf16_f32 v176, v176, v177
    v_cvt_pk_bf16_f32 v177, v178, v179
    v_cvt_pk_bf16_f32 v178, v180, v181
    v_cvt_pk_bf16_f32 v179, v182, v183
    buffer_store_dwordx4 v[176:179], v5, s[84:87], s11 offen sc1
    v_pk_add_f32 v[144:145], v[128:129], v[130:131]
    v_pk_add_f32 v[146:147], v[132:133], v[134:135]
    v_pk_add_f32 v[144:145], v[144:145], v[146:147]
    v_add_f32 v144, v144, v145
    v_mul_f32 v146, 0xbe000000, v144
    v_pk_add_f32 v[128:129], v[128:129], v[146:147] op_sel_hi:[1,0]
    v_pk_add_f32 v[130:131], v[130:131], v[146:147] op_sel_hi:[1,0]
    v_pk_add_f32 v[132:133], v[132:133], v[146:147] op_sel_hi:[1,0]
    v_pk_add_f32 v[134:135], v[134:135], v[146:147] op_sel_hi:[1,0]
    v_pk_mul_f32 v[148:149], v[128:129], v[128:129]
    v_pk_mul_f32 v[150:151], v[130:131], v[130:131]
    v_pk_fma_f32 v[148:149], v[132:133], v[132:133], v[148:149]
    v_pk_fma_f32 v[150:151], v[134:135], v[134:135], v[150:151]
    v_pk_add_f32 v[148:149], v[148:149], v[150:151]
    v_add_f32 v145, v148, v149
    v_mov_b32 v146, v144
    v_mov_b32 v147, v145
    s_nop 0
    v_permlane16_swap_b32 v144, v146
    v_permlane16_swap_b32 v145, v147
    v_sub_f32 v148, v144, v146
    v_add_f32 v144, v144, v146
    v_add_f32 v145, v145, v147
    v_mul_f32 v148, v148, v148
    v_fmac_f32 v145, 0x3d800000, v148
    v_mov_b32 v146, v144
    v_mov_b32 v147, v145
    s_nop 0
    v_permlane32_swap_b32 v144, v146
    v_permlane32_swap_b32 v145, v147
    v_sub_f32 v148, v144, v146
    v_add_f32 v144, v144, v146
    v_add_f32 v145, v145, v147
    v_mul_f32 v148, v148, v148
    v_fmac_f32 v145, 0x3d000000, v148
    v_lshlrev_b32 v128, 8, v20
    v_mov_b32 v146, v4
    v_mov_b32 v147, v4
    v_mov_b32 v129, 2147483632
    v_cmp_gt_u32 vcc, 16, v1
    s_nop 1
    v_cndmask_b32 v128, v129, v128, vcc
    s_lshl_b32 s11, s32, 4
    s_add_u32 s11, s11, 3407872
    buffer_store_dwordx4 v[144:147], v128, s[84:87], s11 offen sc1
    v_mfma_f32_16x16x32_bf16 v[200:203], a[208:211], v[104:107], v[200:203]
    v_rcp_f32 v6, v114
    v_rcp_f32 v7, v119
    v_mfma_f32_16x16x32_bf16 v[216:219], a[212:215], v[104:107], v[216:219]
    v_mul_f32 v96, v96, v6
    v_mul_f32 v97, v97, v6
    v_mfma_f32_16x16x32_bf16 v[232:235], a[216:219], v[104:107], v[232:235]
    v_mul_f32 v98, v98, v6
    v_mul_f32 v99, v99, v6
    v_mfma_f32_16x16x32_bf16 v[248:251], a[220:223], v[104:107], v[248:251]
    v_cvt_pk_bf16_f32 v108, v96, v97
    v_cvt_pk_bf16_f32 v109, v98, v99
    v_mfma_f32_16x16x32_bf16 v[80:83], v[12:15], v[136:139], v[16:19]
    v_mul_f32 v100, v100, v7
    v_mul_f32 v101, v101, v7
    v_mfma_f32_16x16x32_bf16 v[84:87], v[12:15], v[152:155], v[16:19]
    v_mul_f32 v102, v102, v7
    v_mul_f32 v103, v103, v7
    v_mfma_f32_16x16x32_bf16 v[64:67], v[48:51], v[136:139], 0
    v_cvt_pk_bf16_f32 v110, v100, v101
    v_cvt_pk_bf16_f32 v111, v102, v103
    v_mfma_f32_16x16x32_bf16 v[68:71], v[52:55], v[152:155], 0
    s_nop 0
    v_mfma_f32_16x16x32_bf16 v[204:207], a[208:211], v[108:111], v[204:207]
    v_rcp_f32 v6, v80
    v_rcp_f32 v7, v85
    v_mfma_f32_16x16x32_bf16 v[220:223], a[212:215], v[108:111], v[220:223]
    v_mul_f32 v64, v64, v6
    v_mul_f32 v65, v65, v6
    v_mfma_f32_16x16x32_bf16 v[236:239], a[216:219], v[108:111], v[236:239]
    v_mul_f32 v66, v66, v6
    v_mul_f32 v67, v67, v6
    v_mfma_f32_16x16x32_bf16 v[252:255], a[220:223], v[108:111], v[252:255]
    v_cvt_pk_bf16_f32 v136, v64, v65
    v_cvt_pk_bf16_f32 v137, v66, v67
    v_mfma_f32_16x16x32_bf16 v[112:115], v[12:15], v[140:143], v[16:19]
    v_mul_f32 v68, v68, v7
    v_mul_f32 v69, v69, v7
    v_mfma_f32_16x16x32_bf16 v[116:119], v[12:15], v[156:159], v[16:19]
    v_mul_f32 v70, v70, v7
    v_mul_f32 v71, v71, v7
    v_mfma_f32_16x16x32_bf16 v[96:99], v[48:51], v[140:143], 0
    v_cvt_pk_bf16_f32 v138, v68, v69
    v_cvt_pk_bf16_f32 v139, v70, v71
    v_mfma_f32_16x16x32_bf16 v[100:103], v[52:55], v[156:159], 0
    s_nop 0
    v_mfma_f32_16x16x32_bf16 v[200:203], a[224:227], v[136:139], v[200:203]
    v_rcp_f32 v6, v112
    v_rcp_f32 v7, v117
    v_mfma_f32_16x16x32_bf16 v[216:219], a[228:231], v[136:139], v[216:219]
    v_mul_f32 v96, v96, v6
    v_mul_f32 v97, v97, v6
    v_mfma_f32_16x16x32_bf16 v[232:235], a[232:235], v[136:139], v[232:235]
    v_mul_f32 v98, v98, v6
    v_mul_f32 v99, v99, v6
    v_mfma_f32_16x16x32_bf16 v[248:251], a[236:239], v[136:139], v[248:251]
    v_cvt_pk_bf16_f32 v140, v96, v97
    v_cvt_pk_bf16_f32 v141, v98, v99
    v_mfma_f32_16x16x32_bf16 v[80:83], v[12:15], v[168:171], v[16:19]
    v_mul_f32 v100, v100, v7
    v_mul_f32 v101, v101, v7
    v_mfma_f32_16x16x32_bf16 v[84:87], v[12:15], v[184:187], v[16:19]
    v_mul_f32 v102, v102, v7
    v_mul_f32 v103, v103, v7
    v_mfma_f32_16x16x32_bf16 v[64:67], v[56:59], v[168:171], 0
    v_cvt_pk_bf16_f32 v142, v100, v101
    v_cvt_pk_bf16_f32 v143, v102, v103
    v_mfma_f32_16x16x32_bf16 v[68:71], v[60:63], v[184:187], 0
    s_nop 0
    v_mfma_f32_16x16x32_bf16 v[204:207], a[224:227], v[140:143], v[204:207]
    v_rcp_f32 v6, v82
    v_rcp_f32 v7, v87
    v_mfma_f32_16x16x32_bf16 v[220:223], a[228:231], v[140:143], v[220:223]
    v_mul_f32 v64, v64, v6
    v_mul_f32 v65, v65, v6
    v_mfma_f32_16x16x32_bf16 v[236:239], a[232:235], v[140:143], v[236:239]
    v_mul_f32 v66, v66, v6
    v_mul_f32 v67, v67, v6
    v_mfma_f32_16x16x32_bf16 v[252:255], a[236:239], v[140:143], v[252:255]
    v_cvt_pk_bf16_f32 v168, v64, v65
    v_cvt_pk_bf16_f32 v169, v66, v67
    v_mfma_f32_16x16x32_bf16 v[112:115], v[12:15], v[172:175], v[16:19]
    v_mul_f32 v68, v68, v7
    v_mul_f32 v69, v69, v7
    v_mfma_f32_16x16x32_bf16 v[116:119], v[12:15], v[188:191], v[16:19]
    v_mul_f32 v70, v70, v7
    v_mul_f32 v71, v71, v7
    v_mfma_f32_16x16x32_bf16 v[96:99], v[56:59], v[172:175], 0
    v_cvt_pk_bf16_f32 v170, v68, v69
    v_cvt_pk_bf16_f32 v171, v70, v71
    v_mfma_f32_16x16x32_bf16 v[100:103], v[60:63], v[188:191], 0
    s_lshl_b32 s11, s36, 4
    s_add_u32 s11, s11, s37
    s_lshl_b32 s11, s11, 7
    s_add_u32 s11, s11, 557056
    s_waitcnt vmcnt(1)
    s_barrier
    buffer_store_dword v4, v23, s[84:87], s11 offen sc1
    v_mfma_f32_16x16x32_bf16 v[200:203], a[240:243], v[168:171], v[200:203]
    v_rcp_f32 v6, v114
    v_rcp_f32 v7, v119
    v_mfma_f32_16x16x32_bf16 v[216:219], a[244:247], v[168:171], v[216:219]
    v_mul_f32 v96, v96, v6
    v_mul_f32 v97, v97, v6
    v_mfma_f32_16x16x32_bf16 v[232:235], a[248:251], v[168:171], v[232:235]
    v_mul_f32 v98, v98, v6
    v_mul_f32 v99, v99, v6
    v_mfma_f32_16x16x32_bf16 v[248:251], a[252:255], v[168:171], v[248:251]
    v_cvt_pk_bf16_f32 v172, v96, v97
    v_cvt_pk_bf16_f32 v173, v98, v99
    v_mul_f32 v100, v100, v7
    v_mul_f32 v101, v101, v7
    v_mul_f32 v102, v102, v7
    v_mul_f32 v103, v103, v7
    v_cvt_pk_bf16_f32 v174, v100, v101
    v_cvt_pk_bf16_f32 v175, v102, v103
    s_nop 1
    v_mfma_f32_16x16x32_bf16 v[204:207], a[240:243], v[172:175], v[204:207]
    v_mfma_f32_16x16x32_bf16 v[220:223], a[244:247], v[172:175], v[220:223]
    v_mfma_f32_16x16x32_bf16 v[236:239], a[248:251], v[172:175], v[236:239]
    v_mfma_f32_16x16x32_bf16 v[252:255], a[252:255], v[172:175], v[252:255]
    s_xor_b32 s11, s5, 1
    s_mul_i32 s11, s11, 6144
    s_add_u32 s11, s11, 122880
    v_add_u32 v6, s11, v5
    s_nop 0
    ds_write_b128 v6, v[204:207] offset:0
    ds_write_b128 v6, v[220:223] offset:1024
    s_xor_b32 s11, s5, 2
    s_mul_i32 s11, s11, 6144
    s_add_u32 s11, s11, 124928
    v_add_u32 v6, s11, v5
    ds_write_b128 v6, v[232:235] offset:0
    ds_write_b128 v6, v[248:251] offset:1024
    s_xor_b32 s11, s5, 3
    s_mul_i32 s11, s11, 6144
    s_add_u32 s11, s11, 126976
    v_add_u32 v6, s11, v5
    ds_write_b128 v6, v[236:239] offset:0
    ds_write_b128 v6, v[252:255] offset:1024
    ds_read_b128 v[144:147], v22 offset:4096
    ds_read_b128 v[160:163], v22 offset:8192
    ds_read_b128 v[148:151], v22 offset:4160
    ds_read_b128 v[164:167], v22 offset:8256
    s_waitcnt lgkmcnt(0)
    s_barrier
    s_mul_i32 s11, s5, 6144
    s_add_u32 s11, s11, 122880
    v_add_u32 v6, s11, v5
    ds_read_b128 v[204:207], v6 offset:0
    ds_read_b128 v[220:223], v6 offset:1024
    ds_read_b128 v[232:235], v6 offset:2048
    ds_read_b128 v[248:251], v6 offset:3072
    ds_read_b128 v[236:239], v6 offset:4096
    ds_read_b128 v[252:255], v6 offset:5120
    v_lshlrev_b32 v176, 16, v28
    v_and_b32 v177, s98, v28
    v_lshlrev_b32 v178, 16, v29
    v_and_b32 v179, s98, v29
    v_lshlrev_b32 v180, 16, v30
    v_and_b32 v181, s98, v30
    v_lshlrev_b32 v182, 16, v31
    v_and_b32 v183, s98, v31
    s_waitcnt lgkmcnt(0)
    v_pk_add_f32 v[128:129], v[200:201], v[204:205]
    v_pk_add_f32 v[232:233], v[232:233], v[236:237]
    v_pk_add_f32 v[130:131], v[202:203], v[206:207]
    v_pk_add_f32 v[234:235], v[234:235], v[238:239]
    v_pk_add_f32 v[132:133], v[216:217], v[220:221]
    v_pk_add_f32 v[248:249], v[248:249], v[252:253]
    v_pk_add_f32 v[134:135], v[218:219], v[222:223]
    v_pk_add_f32 v[250:251], v[250:251], v[254:255]
    v_pk_add_f32 v[128:129], v[128:129], v[232:233]
    v_pk_add_f32 v[130:131], v[130:131], v[234:235]
    v_pk_add_f32 v[132:133], v[132:133], v[248:249]
    v_pk_add_f32 v[134:135], v[134:135], v[250:251]
    v_pk_fma_f32 v[128:129], v[128:129], v[144:145], v[176:177]
    v_pk_fma_f32 v[130:131], v[130:131], v[146:147], v[178:179]
    v_pk_fma_f32 v[132:133], v[132:133], v[148:149], v[180:181]
    v_pk_fma_f32 v[134:135], v[134:135], v[150:151], v[182:183]
    v_cvt_pk_bf16_f32 v28, v128, v129
    v_cvt_pk_bf16_f32 v29, v130, v131
    v_cvt_pk_bf16_f32 v30, v132, v133
    v_cvt_pk_bf16_f32 v31, v134, v135
    s_lshl_b32 s11, s31, 14
    s_lshl_b32 s12, s32, 10
    v_lshlrev_b32 v128, 16, v28
    v_and_b32 v129, s98, v28
    v_lshlrev_b32 v130, 16, v29
    v_and_b32 v131, s98, v29
    v_lshlrev_b32 v132, 16, v30
    v_and_b32 v133, s98, v30
    v_lshlrev_b32 v134, 16, v31
    v_and_b32 v135, s98, v31
    s_add_u32 s11, s11, s12
    s_add_u32 s11, s11, 8454144
    v_pk_mul_f32 v[176:177], v[128:129], v[160:161]
    v_pk_mul_f32 v[178:179], v[130:131], v[162:163]
    v_pk_mul_f32 v[180:181], v[132:133], v[164:165]
    v_pk_mul_f32 v[182:183], v[134:135], v[166:167]
    v_cvt_pk_bf16_f32 v176, v176, v177
    v_cvt_pk_bf16_f32 v177, v178, v179
    v_cvt_pk_bf16_f32 v178, v180, v181
    v_cvt_pk_bf16_f32 v179, v182, v183
    buffer_store_dwordx4 v[176:179], v5, s[84:87], s11 offen sc1
    v_pk_add_f32 v[144:145], v[128:129], v[130:131]
    v_pk_add_f32 v[146:147], v[132:133], v[134:135]
    v_pk_add_f32 v[144:145], v[144:145], v[146:147]
    v_add_f32 v144, v144, v145
    v_mul_f32 v146, 0xbe000000, v144
    v_pk_add_f32 v[128:129], v[128:129], v[146:147] op_sel_hi:[1,0]
    v_pk_add_f32 v[130:131], v[130:131], v[146:147] op_sel_hi:[1,0]
    v_pk_add_f32 v[132:133], v[132:133], v[146:147] op_sel_hi:[1,0]
    v_pk_add_f32 v[134:135], v[134:135], v[146:147] op_sel_hi:[1,0]
    v_pk_mul_f32 v[148:149], v[128:129], v[128:129]
    v_pk_mul_f32 v[150:151], v[130:131], v[130:131]
    v_pk_fma_f32 v[148:149], v[132:133], v[132:133], v[148:149]
    v_pk_fma_f32 v[150:151], v[134:135], v[134:135], v[150:151]
    v_pk_add_f32 v[148:149], v[148:149], v[150:151]
    v_add_f32 v145, v148, v149
    v_mov_b32 v146, v144
    v_mov_b32 v147, v145
    s_nop 0
    v_permlane16_swap_b32 v144, v146
    v_permlane16_swap_b32 v145, v147
    v_sub_f32 v148, v144, v146
    v_add_f32 v144, v144, v146
    v_add_f32 v145, v145, v147
    v_mul_f32 v148, v148, v148
    v_fmac_f32 v145, 0x3d800000, v148
    v_mov_b32 v146, v144
    v_mov_b32 v147, v145
    s_nop 0
    v_permlane32_swap_b32 v144, v146
    v_permlane32_swap_b32 v145, v147
    v_sub_f32 v148, v144, v146
    v_add_f32 v144, v144, v146
    v_add_f32 v145, v145, v147
    v_mul_f32 v148, v148, v148
    v_fmac_f32 v145, 0x3d000000, v148
    v_lshlrev_b32 v128, 8, v20
    v_mov_b32 v146, v4
    v_mov_b32 v147, v4
    v_mov_b32 v129, 2147483632
    v_cmp_gt_u32 vcc, 16, v1
    s_nop 1
    v_cndmask_b32 v128, v129, v128, vcc
    s_lshl_b32 s11, s32, 4
    s_add_u32 s11, s11, 3424256
    buffer_store_dwordx4 v[144:147], v128, s[84:87], s11 offen sc1
    s_lshl_b32 s11, s38, 11
    s_add_u32 s11, s11, 557056
    v_lshlrev_b32 v60, 7, v3
    v_add_u32 v60, s11, v60
    buffer_load_dword v61, v60, s[84:87], 0 offen sc1
    s_lshl_b32 s11, s38, 3
    s_add_u32 s11, s11, s5
    s_lshl_b32 s11, s11, 14
    s_add_u32 s11, s11, 8388608
    v_add_u32 v62, s11, v5
    s_lshl_b32 s29, s38, 15
    s_add_u32 s29, s29, 3407872
    s_add_u32 s29, s29, s28
    s_and_b32 s12, s5, 1
    s_lshl_b32 s12, s12, 13
    v_add_u32 v8, s12, v5
    v_xor_b32 v9, 8192, v8
    v_add_u32 v10, 65536, v8
    v_add_u32 v11, 65536, v9
    s_lshl_b32 s11, s5, 7
    s_add_u32 s11, s11, 159744
    v_lshlrev_b32 v53, 3, v2
    v_add_u32 v53, s11, v53
    v_lshlrev_b32 v52, 3, v1
    v_add_u32 v52, 149504, v52
    v_cmp_eq_u32 vcc, 0, v3
    s_nop 1
    v_cndmask_b32 v53, v52, v53, vcc
    v_lshrrev_b32 v6, 3, v3
    v_lshlrev_b32 v7, 10, v6
    v_lshl_add_u32 v7, v2, 4, v7
    v_add_u32 v7, 160768, v7
    s_lshr_b32 s11, s24, 1
    v_add_u32 v13, s11, v7
    ds_read_b128 v[64:67], v13 offset:0
    ds_read_b128 v[68:71], v13 offset:64
    ds_read_b128 v[72:75], v13 offset:128
    ds_read_b128 v[76:79], v13 offset:192
    s_lshr_b32 s11, s25, 1
    v_add_u32 v13, s11, v7
    ds_read_b128 v[80:83], v13 offset:0
    ds_read_b128 v[84:87], v13 offset:64
    ds_read_b128 v[88:91], v13 offset:128
    ds_read_b128 v[92:95], v13 offset:192
    s_lshr_b32 s11, s26, 1
    v_add_u32 v13, s11, v7
    ds_read_b128 v[96:99], v13 offset:0
    ds_read_b128 v[100:103], v13 offset:64
    ds_read_b128 v[104:107], v13 offset:128
    ds_read_b128 v[108:111], v13 offset:192
    s_lshr_b32 s11, s27, 1
    v_add_u32 v13, s11, v7
    ds_read_b128 v[112:115], v13 offset:0
    ds_read_b128 v[116:119], v13 offset:64
    ds_read_b128 v[120:123], v13 offset:128
    ds_read_b128 v[124:127], v13 offset:192
    s_mul_i32 s11, s5, 384
    s_add_u32 s11, s11, 147456
    v_lshlrev_b32 v6, 6, v6
    v_lshl_add_u32 v6, v2, 4, v6
    v_add_u32 v6, s11, v6
    v_add_u32 v55, 149504, v5
    v_and_b32 v13, 7, v3
    v_cmp_eq_u32 vcc, 0, v13
    s_nop 1
    v_cndmask_b32 v55, v55, v6, vcc
    s_waitcnt lgkmcnt(0)
    v_mfma_f32_16x16x32_bf16 v[192:195], a[0:3], v[64:67], 0
    v_lshrrev_b32 v6, 3, v1
    v_bfe_u32 v7, v1, 4, 1
    v_bfe_u32 v17, v1, 1, 2
    v_mfma_f32_16x16x32_bf16 v[196:199], a[4:7], v[64:67], 0
    v_xor_b32 v17, v17, v7
    v_and_b32 v18, 1, v1
    v_mfma_f32_16x16x32_bf16 v[200:203], a[8:11], v[64:67], 0
    v_lshlrev_b32 v18, 4, v18
    v_lshl_add_u32 v18, v17, 5, v18
    v_mfma_f32_16x16x32_bf16 v[192:195], a[12:15], v[68:71], v[192:195]
    v_mul_u32_u24 v6, 1024, v6
    v_add_u32 v12, v6, v18
    v_mfma_f32_16x16x32_bf16 v[196:199], a[16:19], v[68:71], v[196:199]
    v_xor_b32 v18, 64, v18
    v_add_u32 v13, v6, v18
    v_mfma_f32_16x16x32_bf16 v[200:203], a[20:23], v[68:71], v[200:203]
    v_add_u32 v13, 7168, v13
    v_add_u32 v14, 14336, v12
    v_mfma_f32_16x16x32_bf16 v[192:195], a[24:27], v[72:75], v[192:195]
    v_add_u32 v15, 14336, v13
    s_mul_i32 s42, s5, 360448
    v_mfma_f32_16x16x32_bf16 v[196:199], a[28:31], v[72:75], v[196:199]
    s_lshl_b32 s43, s9, 7
    s_add_u32 s42, s42, s43
    v_mfma_f32_16x16x32_bf16 v[200:203], a[32:35], v[72:75], v[200:203]
    v_bfe_u32 v6, v1, 2, 2
    v_lshl_add_u32 v6, v2, 3, v6
    v_mfma_f32_16x16x32_bf16 v[192:195], a[36:39], v[76:79], v[192:195]
    v_lshlrev_b32 v6, 7, v6
    v_bfe_u32 v7, v1, 3, 2
    v_mfma_f32_16x16x32_bf16 v[196:199], a[40:43], v[76:79], v[196:199]
    s_and_b32 s43, s5, 2
    v_xor_b32 v7, s43, v7
    v_mfma_f32_16x16x32_bf16 v[200:203], a[44:47], v[76:79], v[200:203]
    v_lshl_add_u32 v6, v7, 5, v6
    v_and_b32 v7, 3, v1
    v_mfma_f32_16x16x32_bf16 v[192:195], a[48:51], v[80:83], v[192:195]
    v_lshl_add_u32 v6, v7, 3, v6
    v_add_u32 v16, s28, v6
    v_mfma_f32_16x16x32_bf16 v[196:199], a[52:55], v[80:83], v[196:199]
    v_xor_b32 v17, 32, v16
    v_xor_b32 v18, 64, v16
    v_mfma_f32_16x16x32_bf16 v[200:203], a[56:59], v[80:83], v[200:203]
    v_xor_b32 v19, 96, v16
    s_and_b32 s12, s5, 1
    v_mfma_f32_16x16x32_bf16 v[192:195], a[60:63], v[84:87], v[192:195]
    s_lshl_b32 s12, s12, 8
    s_add_u32 s12, s12, 159744
    v_mfma_f32_16x16x32_bf16 v[196:199], a[64:67], v[84:87], v[196:199]
    v_lshlrev_b32 v56, 3, v3
    v_add_u32 v56, s12, v56
    v_mfma_f32_16x16x32_bf16 v[200:203], a[68:71], v[84:87], v[200:203]
    s_mul_i32 s11, s5, 384
    s_add_u32 s11, s11, 147456
    v_mfma_f32_16x16x32_bf16 v[192:195], a[72:75], v[88:91], v[192:195]
    v_lshlrev_b32 v57, 4, v2
    v_add_u32 v57, s11, v57
    v_mfma_f32_16x16x32_bf16 v[196:199], a[76:79], v[88:91], v[196:199]
    s_lshl_b32 s11, s5, 11
    s_add_u32 s11, s11, 131072
    v_mfma_f32_16x16x32_bf16 v[200:203], a[80:83], v[88:91], v[200:203]
    v_add_u32 v58, s11, v5
    v_and_b32 v59, 1, v2
    v_mfma_f32_16x16x32_bf16 v[192:195], a[84:87], v[92:95], v[192:195]
    v_mul_u32_u24 v59, 44032, v59
    v_lshrrev_b32 v63, 1, v2
    v_mfma_f32_16x16x32_bf16 v[196:199], a[88:91], v[92:95], v[196:199]
    v_lshl_add_u32 v59, v63, 8, v59
    v_lshl_add_u32 v59, v3, 4, v59
    v_mfma_f32_16x16x32_bf16 v[200:203], a[92:95], v[92:95], v[200:203]
    s_mul_i32 s11, s38, 352256
    s_add_u32 s11, s11, 10485760
    v_mfma_f32_16x16x32_bf16 v[192:195], a[96:99], v[96:99], v[192:195]
    s_add_u32 s30, s33, s40
    s_lshl_b32 s30, s30, 9
    v_mfma_f32_16x16x32_bf16 v[196:199], a[100:103], v[96:99], v[196:199]
    s_add_u32 s30, s30, s11
    s_add_u32 s34, s33, s41
    v_mfma_f32_16x16x32_bf16 v[200:203], a[104:107], v[96:99], v[200:203]
    s_lshl_b32 s34, s34, 9
    s_add_u32 s34, s34, s11
    s_lshl_b32 s11, s36, 4
    s_add_u32 s11, s11, s37
    s_lshl_b32 s11, s11, 7
    s_add_u32 s11, s11, 622592
    s_waitcnt vmcnt(2)
    s_barrier
    buffer_store_dword v4, v23, s[84:87], s11 offen sc1
    s_waitcnt vmcnt(1)
    v_cmp_ne_u32 vcc, v61, v4
    s_cbranch_vccz Ldone_12
    s_mov_b32 s15, 0
    s_nop 3
Lspin_11:
    buffer_load_dword v61, v60, s[84:87], 0 offen sc1
    s_waitcnt vmcnt(0)
    v_cmp_ne_u32 vcc, v61, v4
    s_cbranch_vccz Ldone_12
    s_add_u32 s15, s15, 1
    s_cmp_lt_u32 s15, 400000
    s_cbranch_scc1 Lspin_11
Ldone_12:
    s_nop 1
    s_add_u32 m0, s28, 0
    s_add_u32 s35, s16, 0
    buffer_load_dwordx4 v62, s[84:87], s35 offen offset:0 sc1 lds
    buffer_load_dwordx4 v62, s[84:87], s35 offen offset:1024 sc1 lds
    buffer_load_dwordx4 v62, s[84:87], s35 offen offset:2048 sc1 lds
    buffer_load_dwordx4 v62, s[84:87], s35 offen offset:3072 sc1 lds
    v_mfma_f32_16x16x32_bf16 v[192:195], a[108:111], v[100:103], v[192:195]
    s_add_u32 s14, s29, 0
    buffer_load_dwordx4 v[32:35], v5, s[84:87], s14 offen offset:0 sc1
    v_mfma_f32_16x16x32_bf16 v[196:199], a[112:115], v[100:103], v[196:199]
    buffer_load_dwordx4 v[36:39], v5, s[84:87], s14 offen offset:1024 sc1
    buffer_load_dwordx4 v[40:43], v5, s[84:87], s14 offen offset:2048 sc1
    v_mfma_f32_16x16x32_bf16 v[200:203], a[116:119], v[100:103], v[200:203]
    buffer_load_dwordx4 v[44:47], v5, s[84:87], s14 offen offset:3072 sc1
    s_add_u32 m0, s28, 16384
    v_mfma_f32_16x16x32_bf16 v[192:195], a[120:123], v[104:107], v[192:195]
    s_add_u32 s35, s17, 0
    buffer_load_dwordx4 v62, s[84:87], s35 offen offset:0 sc1 lds
    v_mfma_f32_16x16x32_bf16 v[196:199], a[124:127], v[104:107], v[196:199]
    buffer_load_dwordx4 v62, s[84:87], s35 offen offset:1024 sc1 lds
    buffer_load_dwordx4 v62, s[84:87], s35 offen offset:2048 sc1 lds
    v_mfma_f32_16x16x32_bf16 v[200:203], a[128:131], v[104:107], v[200:203]
    buffer_load_dwordx4 v62, s[84:87], s35 offen offset:3072 sc1 lds
    v_mfma_f32_16x16x32_bf16 v[192:195], a[132:135], v[108:111], v[192:195]
    v_mfma_f32_16x16x32_bf16 v[196:199], a[136:139], v[108:111], v[196:199]
    s_add_u32 m0, s28, 32768
    s_add_u32 s35, s18, 0
    v_mfma_f32_16x16x32_bf16 v[200:203], a[140:143], v[108:111], v[200:203]
    buffer_load_dwordx4 v62, s[84:87], s35 offen offset:0 sc1 lds
    v_mfma_f32_16x16x32_bf16 v[192:195], a[144:147], v[112:115], v[192:195]
    buffer_load_dwordx4 v62, s[84:87], s35 offen offset:1024 sc1 lds
    v_mfma_f32_16x16x32_bf16 v[196:199], a[148:151], v[112:115], v[196:199]
    buffer_load_dwordx4 v62, s[84:87], s35 offen offset:2048 sc1 lds
    v_mfma_f32_16x16x32_bf16 v[200:203], a[152:155], v[112:115], v[200:203]
    v_mfma_f32_16x16x32_bf16 v[192:195], a[156:159], v[116:119], v[192:195]
    buffer_load_dwordx4 v62, s[84:87], s35 offen offset:3072 sc1 lds
    v_mfma_f32_16x16x32_bf16 v[196:199], a[160:163], v[116:119], v[196:199]
    v_mfma_f32_16x16x32_bf16 v[200:203], a[164:167], v[116:119], v[200:203]
    s_add_u32 m0, s28, 49152
    s_add_u32 s35, s19, 0
    v_mfma_f32_16x16x32_bf16 v[192:195], a[168:171], v[120:123], v[192:195]
    buffer_load_dwordx4 v62, s[84:87], s35 offen offset:0 sc1 lds
    buffer_load_dwordx4 v62, s[84:87], s35 offen offset:1024 sc1 lds
    v_mfma_f32_16x16x32_bf16 v[196:199], a[172:175], v[120:123], v[196:199]
    v_mfma_f32_16x16x32_bf16 v[200:203], a[176:179], v[120:123], v[200:203]
    buffer_load_dwordx4 v62, s[84:87], s35 offen offset:2048 sc1 lds
    v_mfma_f32_16x16x32_bf16 v[192:195], a[180:183], v[124:127], v[192:195]
    v_mfma_f32_16x16x32_bf16 v[196:199], a[184:187], v[124:127], v[196:199]
    buffer_load_dwordx4 v62, s[84:87], s35 offen offset:3072 sc1 lds
    v_mfma_f32_16x16x32_bf16 v[200:203], a[188:191], v[124:127], v[200:203]
    s_nop 4
    ds_write_b128 v55, v[192:195] offset:0
    ds_write_b128 v55, v[196:199] offset:128
    s_nop 0
    ds_write_b128 v55, v[200:203] offset:256
    v_add_u32 v60, 0x10000, v60
    s_waitcnt vmcnt(16)
    s_waitcnt lgkmcnt(0)
    s_barrier
    ds_read_b128 v[64:67], v8 offset:0
    ds_read_b128 v[68:71], v8 offset:4096
    ds_read_b128 v[72:75], v9 offset:0
    ds_read_b128 v[76:79], v9 offset:4096
    ds_read_b128 v[80:83], v8 offset:1024
    ds_read_b128 v[84:87], v8 offset:5120
    ds_read_b128 v[88:91], v9 offset:1024
    ds_read_b128 v[92:95], v9 offset:5120
    ds_read_b128 v[96:99], v8 offset:2048
    s_waitcnt lgkmcnt(5)
    v_mfma_f32_16x16x32_bf16 v[128:131], a[0:3], v[64:67], 0
    s_add_u32 m0, s28, 98304
    s_add_u32 s35, s42, 0
    v_mfma_f32_16x16x32_bf16 v[144:147], a[4:7], v[64:67], 0
    buffer_load_dwordx4 v12, s[68:71], s35 offen offset:0 lds
    v_mfma_f32_16x16x32_bf16 v[160:163], a[8:11], v[64:67], 0
    ds_read_b128 v[100:103], v8 offset:6144
    v_mfma_f32_16x16x32_bf16 v[132:135], a[0:3], v[68:71], 0
    v_mfma_f32_16x16x32_bf16 v[148:151], a[4:7], v[68:71], 0
    v_mfma_f32_16x16x32_bf16 v[164:167], a[8:11], v[68:71], 0
    ds_read_b128 v[104:107], v9 offset:2048
    v_mfma_f32_16x16x32_bf16 v[136:139], a[0:3], v[72:75], 0
    buffer_load_dwordx4 v13, s[68:71], s35 offen offset:1024 lds
    v_mfma_f32_16x16x32_bf16 v[152:155], a[4:7], v[72:75], 0
    v_mfma_f32_16x16x32_bf16 v[168:171], a[8:11], v[72:75], 0
    ds_read_b128 v[108:111], v9 offset:6144
    v_mfma_f32_16x16x32_bf16 v[140:143], a[0:3], v[76:79], 0
    v_mfma_f32_16x16x32_bf16 v[156:159], a[4:7], v[76:79], 0
    v_mfma_f32_16x16x32_bf16 v[172:175], a[8:11], v[76:79], 0
    ds_read_b128 v[64:67], v8 offset:3072
    s_waitcnt lgkmcnt(5)
    v_mfma_f32_16x16x32_bf16 v[128:131], a[12:15], v[80:83], v[128:131]
    buffer_load_dwordx4 v14, s[68:71], s35 offen offset:2048 lds
    v_mfma_f32_16x16x32_bf16 v[144:147], a[16:19], v[80:83], v[144:147]
    v_mfma_f32_16x16x32_bf16 v[160:163], a[20:23], v[80:83], v[160:163]
    ds_read_b128 v[68:71], v8 offset:7168
    v_mfma_f32_16x16x32_bf16 v[132:135], a[12:15], v[84:87], v[132:135]
    v_mfma_f32_16x16x32_bf16 v[148:151], a[16:19], v[84:87], v[148:151]
    v_mfma_f32_16x16x32_bf16 v[164:167], a[20:23], v[84:87], v[164:167]
    buffer_load_dwordx4 v15, s[68:71], s35 offen offset:3072 lds
    ds_read_b128 v[72:75], v9 offset:3072
    v_mfma_f32_16x16x32_bf16 v[136:139], a[12:15], v[88:91], v[136:139]
    v_mfma_f32_16x16x32_bf16 v[152:155], a[16:19], v[88:91], v[152:155]
    v_mfma_f32_16x16x32_bf16 v[168:171], a[20:23], v[88:91], v[168:171]
    ds_read_b128 v[76:79], v9 offset:7168
    v_mfma_f32_16x16x32_bf16 v[140:143], a[12:15], v[92:95], v[140:143]
    v_mfma_f32_16x16x32_bf16 v[156:159], a[16:19], v[92:95], v[156:159]
    v_mfma_f32_16x16x32_bf16 v[172:175], a[20:23], v[92:95], v[172:175]
    buffer_load_dword v61, v60, s[84:87], 0 offen sc1
    s_waitcnt vmcnt(13)
    s_barrier
    ds_read_b128 v[80:83], v8 offset:16384
    s_waitcnt lgkmcnt(5)
    v_mfma_f32_16x16x32_bf16 v[128:131], a[24:27], v[96:99], v[128:131]
    s_add_u32 m0, s28, 114688
    s_add_u32 s35, s42, 32768
    v_mfma_f32_16x16x32_bf16 v[144:147], a[28:31], v[96:99], v[144:147]
    buffer_load_dwordx4 v12, s[68:71], s35 offen offset:0 lds
    v_mfma_f32_16x16x32_bf16 v[160:163], a[32:35], v[96:99], v[160:163]
    ds_read_b128 v[84:87], v8 offset:20480
    v_mfma_f32_16x16x32_bf16 v[132:135], a[24:27], v[100:103], v[132:135]
    v_mfma_f32_16x16x32_bf16 v[148:151], a[28:31], v[100:103], v[148:151]
    v_mfma_f32_16x16x32_bf16 v[164:167], a[32:35], v[100:103], v[164:167]
    ds_read_b128 v[88:91], v9 offset:16384
    v_mfma_f32_16x16x32_bf16 v[136:139], a[24:27], v[104:107], v[136:139]
    buffer_load_dwordx4 v13, s[68:71], s35 offen offset:1024 lds
    v_mfma_f32_16x16x32_bf16 v[152:155], a[28:31], v[104:107], v[152:155]
    v_mfma_f32_16x16x32_bf16 v[168:171], a[32:35], v[104:107], v[168:171]
    ds_read_b128 v[92:95], v9 offset:20480
    v_mfma_f32_16x16x32_bf16 v[140:143], a[24:27], v[108:111], v[140:143]
    v_mfma_f32_16x16x32_bf16 v[156:159], a[28:31], v[108:111], v[156:159]
    v_mfma_f32_16x16x32_bf16 v[172:175], a[32:35], v[108:111], v[172:175]
    ds_read_b128 v[96:99], v8 offset:17408
    s_waitcnt lgkmcnt(5)
    v_mfma_f32_16x16x32_bf16 v[128:131], a[36:39], v[64:67], v[128:131]
    buffer_load_dwordx4 v14, s[68:71], s35 offen offset:2048 lds
    v_mfma_f32_16x16x32_bf16 v[144:147], a[40:43], v[64:67], v[144:147]
    v_mfma_f32_16x16x32_bf16 v[160:163], a[44:47], v[64:67], v[160:163]
    ds_read_b128 v[100:103], v8 offset:21504
    v_mfma_f32_16x16x32_bf16 v[132:135], a[36:39], v[68:71], v[132:135]
    v_mfma_f32_16x16x32_bf16 v[148:151], a[40:43], v[68:71], v[148:151]
    v_mfma_f32_16x16x32_bf16 v[164:167], a[44:47], v[68:71], v[164:167]
    ds_read_b128 v[104:107], v9 offset:17408
    v_mfma_f32_16x16x32_bf16 v[136:139], a[36:39], v[72:75], v[136:139]
    buffer_load_dwordx4 v15, s[68:71], s35 offen offset:3072 lds
    v_mfma_f32_16x16x32_bf16 v[152:155], a[40:43], v[72:75], v[152:155]
    v_mfma_f32_16x16x32_bf16 v[168:171], a[44:47], v[72:75], v[168:171]
    ds_read_b128 v[108:111], v9 offset:21504
    v_mfma_f32_16x16x32_bf16 v[140:143], a[36:39], v[76:79], v[140:143]
    v_mfma_f32_16x16x32_bf16 v[156:159], a[40:43], v[76:79], v[156:159]
    v_mfma_f32_16x16x32_bf16 v[172:175], a[44:47], v[76:79], v[172:175]
    s_barrier
    ds_read_b128 v[64:67], v8 offset:18432
    s_waitcnt lgkmcnt(5)
    v_mfma_f32_16x16x32_bf16 v[128:131], a[48:51], v[80:83], v[128:131]
    s_add_u32 m0, s28, 0
    s_add_u32 s35, s42, 65536
    v_mfma_f32_16x16x32_bf16 v[144:147], a[52:55], v[80:83], v[144:147]
    buffer_load_dwordx4 v12, s[68:71], s35 offen offset:0 lds
    v_mfma_f32_16x16x32_bf16 v[160:163], a[56:59], v[80:83], v[160:163]
    ds_read_b128 v[68:71], v8 offset:22528
    v_mfma_f32_16x16x32_bf16 v[132:135], a[48:51], v[84:87], v[132:135]
    v_mfma_f32_16x16x32_bf16 v[148:151], a[52:55], v[84:87], v[148:151]
    v_mfma_f32_16x16x32_bf16 v[164:167], a[56:59], v[84:87], v[164:167]
    ds_read_b128 v[72:75], v9 offset:18432
    v_mfma_f32_16x16x32_bf16 v[136:139], a[48:51], v[88:91], v[136:139]
    buffer_load_dwordx4 v13, s[68:71], s35 offen offset:1024 lds
    v_mfma_f32_16x16x32_bf16 v[152:155], a[52:55], v[88:91], v[152:155]
    v_mfma_f32_16x16x32_bf16 v[168:171], a[56:59], v[88:91], v[168:171]
    ds_read_b128 v[76:79], v9 offset:22528
    v_mfma_f32_16x16x32_bf16 v[140:143], a[48:51], v[92:95], v[140:143]
    v_mfma_f32_16x16x32_bf16 v[156:159], a[52:55], v[92:95], v[156:159]
    v_mfma_f32_16x16x32_bf16 v[172:175], a[56:59], v[92:95], v[172:175]
    ds_read_b128 v[80:83], v8 offset:19456
    s_waitcnt lgkmcnt(5)
    v_mfma_f32_16x16x32_bf16 v[128:131], a[60:63], v[96:99], v[128:131]
    buffer_load_dwordx4 v14, s[68:71], s35 offen offset:2048 lds
    v_mfma_f32_16x16x32_bf16 v[144:147], a[64:67], v[96:99], v[144:147]
    v_mfma_f32_16x16x32_bf16 v[160:163], a[68:71], v[96:99], v[160:163]
    ds_read_b128 v[84:87], v8 offset:23552
    v_mfma_f32_16x16x32_bf16 v[132:135], a[60:63], v[100:103], v[132:135]
    v_mfma_f32_16x16x32_bf16 v[148:151], a[64:67], v[100:103], v[148:151]
    v_mfma_f32_16x16x32_bf16 v[164:167], a[68:71], v[100:103], v[164:167]
    ds_read_b128 v[88:91], v9 offset:19456
    v_mfma_f32_16x16x32_bf16 v[136:139], a[60:63], v[104:107], v[136:139]
    buffer_load_dwordx4 v15, s[68:71], s35 offen offset:3072 lds
    v_mfma_f32_16x16x32_bf16 v[152:155], a[64:67], v[104:107], v[152:155]
    v_mfma_f32_16x16x32_bf16 v[168:171], a[68:71], v[104:107], v[168:171]
    ds_read_b128 v[92:95], v9 offset:23552
    v_mfma_f32_16x16x32_bf16 v[140:143], a[60:63], v[108:111], v[140:143]
    v_mfma_f32_16x16x32_bf16 v[156:159], a[64:67], v[108:111], v[156:159]
    v_mfma_f32_16x16x32_bf16 v[172:175], a[68:71], v[108:111], v[172:175]
    s_waitcnt vmcnt(8)
    v_cmp_ne_u32 vcc, v61, v4
    s_cbranch_vccz Ldone_14
    s_mov_b32 s15, 0
    s_nop 3
Lspin_13:
    buffer_load_dword v61, v60, s[84:87], 0 offen sc1
    s_waitcnt vmcnt(0)
    v_cmp_ne_u32 vcc, v61, v4
    s_cbranch_vccz Ldone_14
    s_add_u32 s15, s15, 1
    s_cmp_lt_u32 s15, 400000
    s_cbranch_scc1 Lspin_13
Ldone_14:
    s_nop 1
    v_xor_b32 v6, v34, v4
    v_bitop3_b32 v6, v6, v38, v4 bitop3:0xf6
    v_bitop3_b32 v6, v6, v42, v4 bitop3:0xf6
    v_bitop3_b32 v6, v6, v46, v4 bitop3:0xf6
    v_cmp_ne_u32 vcc, 0, v6
    s_cbranch_vccz Ldone_16
    s_mov_b32 s15, 0
    s_nop 3
Lspin_15:
    s_add_u32 s14, s29, 0
    buffer_load_dwordx4 v[32:35], v5, s[84:87], s14 offen offset:0 sc1
    buffer_load_dwordx4 v[36:39], v5, s[84:87], s14 offen offset:1024 sc1
    buffer_load_dwordx4 v[40:43], v5, s[84:87], s14 offen offset:2048 sc1
    buffer_load_dwordx4 v[44:47], v5, s[84:87], s14 offen offset:3072 sc1
    s_waitcnt vmcnt(0)
    v_xor_b32 v6, v34, v4
    v_bitop3_b32 v6, v6, v38, v4 bitop3:0xf6
    v_bitop3_b32 v6, v6, v42, v4 bitop3:0xf6
    v_bitop3_b32 v6, v6, v46, v4 bitop3:0xf6
    v_cmp_ne_u32 vcc, 0, v6
    s_cbranch_vccz Ldone_16
    s_add_u32 s15, s15, 1
    s_cmp_lt_u32 s15, 400000
    s_cbranch_scc1 Lspin_15
Ldone_16:
    s_nop 1
    s_barrier
    ds_read_b128 v[96:99], v8 offset:32768
    s_waitcnt lgkmcnt(5)
    v_mfma_f32_16x16x32_bf16 v[128:131], a[72:75], v[64:67], v[128:131]
    s_add_u32 m0, s28, 65536
    s_add_u32 s35, s16, 65536
    v_mfma_f32_16x16x32_bf16 v[144:147], a[76:79], v[64:67], v[144:147]
    buffer_load_dwordx4 v62, s[84:87], s35 offen offset:0 sc1 lds
    v_mfma_f32_16x16x32_bf16 v[160:163], a[80:83], v[64:67], v[160:163]
    ds_read_b128 v[100:103], v8 offset:36864
    v_mfma_f32_16x16x32_bf16 v[132:135], a[72:75], v[68:71], v[132:135]
    buffer_load_dwordx4 v62, s[84:87], s35 offen offset:1024 sc1 lds
    buffer_load_dwordx4 v62, s[84:87], s35 offen offset:2048 sc1 lds
    v_mfma_f32_16x16x32_bf16 v[148:151], a[76:79], v[68:71], v[148:151]
    buffer_load_dwordx4 v62, s[84:87], s35 offen offset:3072 sc1 lds
    v_mov_b32 v34, v32
    v_mfma_f32_16x16x32_bf16 v[164:167], a[80:83], v[68:71], v[164:167]
    v_mov_b32 v38, v36
    ds_read_b128 v[104:107], v9 offset:32768
    v_mfma_f32_16x16x32_bf16 v[136:139], a[72:75], v[72:75], v[136:139]
    v_mov_b32 v42, v40
    v_mov_b32 v46, v44
    v_mfma_f32_16x16x32_bf16 v[152:155], a[76:79], v[72:75], v[152:155]
    v_add_f32_dpp v34, v34, v34 row_ror:8 row_mask:0xf bank_mask:0xf
    v_add_f32_dpp v38, v38, v38 row_ror:8 row_mask:0xf bank_mask:0xf
    v_mfma_f32_16x16x32_bf16 v[168:171], a[80:83], v[72:75], v[168:171]
    v_add_f32_dpp v42, v42, v42 row_ror:8 row_mask:0xf bank_mask:0xf
    ds_read_b128 v[108:111], v9 offset:36864
    v_mfma_f32_16x16x32_bf16 v[140:143], a[72:75], v[76:79], v[140:143]
    v_add_f32_dpp v46, v46, v46 row_ror:8 row_mask:0xf bank_mask:0xf
    v_add_f32_dpp v34, v34, v34 row_ror:4 row_mask:0xf bank_mask:0xf
    v_mfma_f32_16x16x32_bf16 v[156:159], a[76:79], v[76:79], v[156:159]
    v_add_f32_dpp v38, v38, v38 row_ror:4 row_mask:0xf bank_mask:0xf
    v_add_f32_dpp v42, v42, v42 row_ror:4 row_mask:0xf bank_mask:0xf
    v_mfma_f32_16x16x32_bf16 v[172:175], a[80:83], v[76:79], v[172:175]
    ds_read_b128 v[64:67], v8 offset:33792
    s_waitcnt lgkmcnt(5)
    v_mfma_f32_16x16x32_bf16 v[128:131], a[84:87], v[80:83], v[128:131]
    v_add_f32_dpp v46, v46, v46 row_ror:4 row_mask:0xf bank_mask:0xf
    v_add_f32_dpp v34, v34, v34 row_ror:2 row_mask:0xf bank_mask:0xf
    v_mfma_f32_16x16x32_bf16 v[144:147], a[88:91], v[80:83], v[144:147]
    v_add_f32_dpp v38, v38, v38 row_ror:2 row_mask:0xf bank_mask:0xf
    v_add_f32_dpp v42, v42, v42 row_ror:2 row_mask:0xf bank_mask:0xf
    v_mfma_f32_16x16x32_bf16 v[160:163], a[92:95], v[80:83], v[160:163]
    v_add_f32_dpp v46, v46, v46 row_ror:2 row_mask:0xf bank_mask:0xf
    ds_read_b128 v[68:71], v8 offset:37888
    v_mfma_f32_16x16x32_bf16 v[132:135], a[84:87], v[84:87], v[132:135]
    v_add_f32_dpp v34, v34, v34 row_ror:1 row_mask:0xf bank_mask:0xf
    v_add_f32_dpp v38, v38, v38 row_ror:1 row_mask:0xf bank_mask:0xf
    v_mfma_f32_16x16x32_bf16 v[148:151], a[88:91], v[84:87], v[148:151]
    v_add_f32_dpp v42, v42, v42 row_ror:1 row_mask:0xf bank_mask:0xf
    v_add_f32_dpp v46, v46, v46 row_ror:1 row_mask:0xf bank_mask:0xf
    v_mfma_f32_16x16x32_bf16 v[164:167], a[92:95], v[84:87], v[164:167]
    v_fmac_f32 v32, 0xbd800000, v34
    ds_read_b128 v[72:75], v9 offset:33792
    v_mfma_f32_16x16x32_bf16 v[136:139], a[84:87], v[88:91], v[136:139]
    v_fmac_f32 v36, 0xbd800000, v38
    v_fmac_f32 v40, 0xbd800000, v42
    v_mfma_f32_16x16x32_bf16 v[152:155], a[88:91], v[88:91], v[152:155]
    v_fmac_f32 v44, 0xbd800000, v46
    v_mul_f32 v32, v32, v32
    v_mfma_f32_16x16x32_bf16 v[168:171], a[92:95], v[88:91], v[168:171]
    v_mul_f32 v36, v36, v36
    ds_read_b128 v[76:79], v9 offset:37888
    v_mfma_f32_16x16x32_bf16 v[140:143], a[84:87], v[92:95], v[140:143]
    v_mul_f32 v40, v40, v40
    v_mul_f32 v44, v44, v44
    v_mfma_f32_16x16x32_bf16 v[156:159], a[88:91], v[92:95], v[156:159]
    v_fmac_f32 v33, 0x3d000000, v32
    v_fmac_f32 v37, 0x3d000000, v36
    v_mfma_f32_16x16x32_bf16 v[172:175], a[92:95], v[92:95], v[172:175]
    v_fmac_f32 v41, 0x3d000000, v40
    v_fmac_f32 v45, 0x3d000000, v44
    s_barrier
    ds_read_b128 v[80:83], v8 offset:34816
    s_waitcnt lgkmcnt(5)
    v_mfma_f32_16x16x32_bf16 v[128:131], a[96:99], v[96:99], v[128:131]
    s_add_u32 m0, s28, 81920
    s_add_u32 s35, s17, 65536
    v_mfma_f32_16x16x32_bf16 v[144:147], a[100:103], v[96:99], v[144:147]
    buffer_load_dwordx4 v62, s[84:87], s35 offen offset:0 sc1 lds
    v_mfma_f32_16x16x32_bf16 v[160:163], a[104:107], v[96:99], v[160:163]
    ds_read_b128 v[84:87], v8 offset:38912
    v_mfma_f32_16x16x32_bf16 v[132:135], a[96:99], v[100:103], v[132:135]
    v_mfma_f32_16x16x32_bf16 v[148:151], a[100:103], v[100:103], v[148:151]
    v_mfma_f32_16x16x32_bf16 v[164:167], a[104:107], v[100:103], v[164:167]
    buffer_load_dwordx4 v62, s[84:87], s35 offen offset:1024 sc1 lds
    ds_read_b128 v[88:91], v9 offset:34816
    v_mfma_f32_16x16x32_bf16 v[136:139], a[96:99], v[104:107], v[136:139]
    v_mfma_f32_16x16x32_bf16 v[152:155], a[100:103], v[104:107], v[152:155]
    buffer_load_dwordx4 v62, s[84:87], s35 offen offset:2048 sc1 lds
    buffer_load_dwordx4 v62, s[84:87], s35 offen offset:3072 sc1 lds
    v_mfma_f32_16x16x32_bf16 v[168:171], a[104:107], v[104:107], v[168:171]
    v_xor_b32 v16, 65536, v16
    ds_read_b128 v[92:95], v9 offset:38912
    v_mfma_f32_16x16x32_bf16 v[140:143], a[96:99], v[108:111], v[140:143]
    v_xor_b32 v17, 65536, v17
    v_xor_b32 v18, 65536, v18
    v_mfma_f32_16x16x32_bf16 v[156:159], a[100:103], v[108:111], v[156:159]
    v_xor_b32 v19, 65536, v19
    v_mfma_f32_16x16x32_bf16 v[172:175], a[104:107], v[108:111], v[172:175]
    ds_read_b128 v[96:99], v8 offset:35840
    s_waitcnt lgkmcnt(5)
    v_mfma_f32_16x16x32_bf16 v[128:131], a[108:111], v[64:67], v[128:131]
    ds_read_b64_tr_b16 a[192:193], v16 offset:32768
    ds_read_b64_tr_b16 a[194:195], v16 offset:33280
    v_mfma_f32_16x16x32_bf16 v[144:147], a[112:115], v[64:67], v[144:147]
    ds_read_b64_tr_b16 a[196:197], v17 offset:32768
    ds_read_b64_tr_b16 a[198:199], v17 offset:33280
    v_mfma_f32_16x16x32_bf16 v[160:163], a[116:119], v[64:67], v[160:163]
    ds_read_b64_tr_b16 a[200:201], v18 offset:32768
    ds_read_b128 v[100:103], v8 offset:39936
    v_mfma_f32_16x16x32_bf16 v[132:135], a[108:111], v[68:71], v[132:135]
    ds_read_b64_tr_b16 a[202:203], v18 offset:33280
    ds_read_b64_tr_b16 a[204:205], v19 offset:32768
    v_mfma_f32_16x16x32_bf16 v[148:151], a[112:115], v[68:71], v[148:151]
    ds_read_b64_tr_b16 a[206:207], v19 offset:33280
    s_waitcnt vmcnt(12)
    v_mfma_f32_16x16x32_bf16 v[164:167], a[116:119], v[68:71], v[164:167]
    ds_read_b64_tr_b16 a[208:209], v16 offset:49152
    ds_read_b128 v[104:107], v9 offset:35840
    v_mfma_f32_16x16x32_bf16 v[136:139], a[108:111], v[72:75], v[136:139]
    ds_read_b64_tr_b16 a[210:211], v16 offset:49664
    ds_read_b64_tr_b16 a[212:213], v17 offset:49152
    v_mfma_f32_16x16x32_bf16 v[152:155], a[112:115], v[72:75], v[152:155]
    ds_read_b64_tr_b16 a[214:215], v17 offset:49664
    ds_read_b64_tr_b16 a[216:217], v18 offset:49152
    v_mfma_f32_16x16x32_bf16 v[168:171], a[116:119], v[72:75], v[168:171]
    ds_read_b64_tr_b16 a[218:219], v18 offset:49664
    ds_read_b128 v[108:111], v9 offset:39936
    v_mfma_f32_16x16x32_bf16 v[140:143], a[108:111], v[76:79], v[140:143]
    ds_read_b64_tr_b16 a[220:221], v19 offset:49152
    ds_read_b64_tr_b16 a[222:223], v19 offset:49664
    v_mfma_f32_16x16x32_bf16 v[156:159], a[112:115], v[76:79], v[156:159]
    v_xor_b32 v16, 65536, v16
    v_xor_b32 v17, 65536, v17
    v_mfma_f32_16x16x32_bf16 v[172:175], a[116:119], v[76:79], v[172:175]
    v_xor_b32 v18, 65536, v18
    v_xor_b32 v19, 65536, v19
    s_barrier
    ds_read_b128 v[64:67], v8 offset:49152
    s_waitcnt lgkmcnt(15)
    v_mfma_f32_16x16x32_bf16 v[128:131], a[120:123], v[80:83], v[128:131]
    s_waitcnt lgkmcnt(1)
    s_add_u32 m0, s28, 98304
    v_mfma_f32_16x16x32_bf16 v[144:147], a[124:127], v[80:83], v[144:147]
    s_add_u32 s35, s18, 65536
    buffer_load_dwordx4 v62, s[84:87], s35 offen offset:0 sc1 lds
    v_mfma_f32_16x16x32_bf16 v[160:163], a[128:131], v[80:83], v[160:163]
    ds_read_b128 v[68:71], v8 offset:53248
    v_mfma_f32_16x16x32_bf16 v[132:135], a[120:123], v[84:87], v[132:135]
    buffer_load_dwordx4 v62, s[84:87], s35 offen offset:1024 sc1 lds
    v_mfma_f32_16x16x32_bf16 v[148:151], a[124:127], v[84:87], v[148:151]
    v_mfma_f32_16x16x32_bf16 v[164:167], a[128:131], v[84:87], v[164:167]
    ds_read_b128 v[72:75], v9 offset:49152
    v_mfma_f32_16x16x32_bf16 v[136:139], a[120:123], v[88:91], v[136:139]
    buffer_load_dwordx4 v62, s[84:87], s35 offen offset:2048 sc1 lds
    v_mfma_f32_16x16x32_bf16 v[152:155], a[124:127], v[88:91], v[152:155]
    v_mfma_f32_16x16x32_bf16 v[168:171], a[128:131], v[88:91], v[168:171]
    ds_read_b128 v[76:79], v9 offset:53248
    v_mfma_f32_16x16x32_bf16 v[140:143], a[120:123], v[92:95], v[140:143]
    buffer_load_dwordx4 v62, s[84:87], s35 offen offset:3072 sc1 lds
    v_mfma_f32_16x16x32_bf16 v[156:159], a[124:127], v[92:95], v[156:159]
    v_mfma_f32_16x16x32_bf16 v[172:175], a[128:131], v[92:95], v[172:175]
    ds_read_b128 v[80:83], v8 offset:50176
    v_mfma_f32_16x16x32_bf16 v[128:131], a[132:135], v[96:99], v[128:131]
    s_add_u32 m0, s28, 16384
    s_add_u32 s35, s42, 98304
    v_mfma_f32_16x16x32_bf16 v[144:147], a[136:139], v[96:99], v[144:147]
    buffer_load_dwordx4 v12, s[68:71], s35 offen offset:0 lds
    v_mfma_f32_16x16x32_bf16 v[160:163], a[140:143], v[96:99], v[160:163]
    ds_read_b128 v[84:87], v8 offset:54272
    v_mfma_f32_16x16x32_bf16 v[132:135], a[132:135], v[100:103], v[132:135]
    buffer_load_dwordx4 v13, s[68:71], s35 offen offset:1024 lds
    v_mfma_f32_16x16x32_bf16 v[148:151], a[136:139], v[100:103], v[148:151]
    v_mfma_f32_16x16x32_bf16 v[164:167], a[140:143], v[100:103], v[164:167]
    ds_read_b128 v[88:91], v9 offset:50176
    v_mfma_f32_16x16x32_bf16 v[136:139], a[132:135], v[104:107], v[136:139]
    buffer_load_dwordx4 v14, s[68:71], s35 offen offset:2048 lds
    v_mfma_f32_16x16x32_bf16 v[152:155], a[136:139], v[104:107], v[152:155]
    v_mfma_f32_16x16x32_bf16 v[168:171], a[140:143], v[104:107], v[168:171]
    ds_read_b128 v[92:95], v9 offset:54272
    v_mfma_f32_16x16x32_bf16 v[140:143], a[132:135], v[108:111], v[140:143]
    buffer_load_dwordx4 v15, s[68:71], s35 offen offset:3072 lds
    v_mfma_f32_16x16x32_bf16 v[156:159], a[136:139], v[108:111], v[156:159]
    v_mfma_f32_16x16x32_bf16 v[172:175], a[140:143], v[108:111], v[172:175]
    s_barrier
    ds_read_b128 v[96:99], v8 offset:51200
    s_waitcnt lgkmcnt(5)
    v_mfma_f32_16x16x32_bf16 v[128:131], a[144:147], v[64:67], v[128:131]
    s_add_u32 m0, s28, 114688
    s_add_u32 s35, s19, 65536
    v_mfma_f32_16x16x32_bf16 v[144:147], a[148:151], v[64:67], v[144:147]
    buffer_load_dwordx4 v62, s[84:87], s35 offen offset:0 sc1 lds
    v_mfma_f32_16x16x32_bf16 v[160:163], a[152:155], v[64:67], v[160:163]
    ds_read_b128 v[100:103], v8 offset:55296
    v_mfma_f32_16x16x32_bf16 v[132:135], a[144:147], v[68:71], v[132:135]
    v_mfma_f32_16x16x32_bf16 v[148:151], a[148:151], v[68:71], v[148:151]
    v_mfma_f32_16x16x32_bf16 v[164:167], a[152:155], v[68:71], v[164:167]
    buffer_load_dwordx4 v62, s[84:87], s35 offen offset:1024 sc1 lds
    ds_read_b128 v[104:107], v9 offset:51200
    v_mfma_f32_16x16x32_bf16 v[136:139], a[144:147], v[72:75], v[136:139]
    v_mfma_f32_16x16x32_bf16 v[152:155], a[148:151], v[72:75], v[152:155]
    v_mfma_f32_16x16x32_bf16 v[168:171], a[152:155], v[72:75], v[168:171]
    ds_read_b128 v[108:111], v9 offset:55296
    v_mfma_f32_16x16x32_bf16 v[140:143], a[144:147], v[76:79], v[140:143]
    v_mfma_f32_16x16x32_bf16 v[156:159], a[148:151], v[76:79], v[156:159]
    v_mfma_f32_16x16x32_bf16 v[172:175], a[152:155], v[76:79], v[172:175]
    ds_read_b128 v[64:67], v8 offset:52224
    s_waitcnt lgkmcnt(5)
    v_mfma_f32_16x16x32_bf16 v[128:131], a[156:159], v[80:83], v[128:131]
    buffer_load_dwordx4 v62, s[84:87], s35 offen offset:2048 sc1 lds
    v_mfma_f32_16x16x32_bf16 v[144:147], a[160:163], v[80:83], v[144:147]
    v_mfma_f32_16x16x32_bf16 v[160:163], a[164:167], v[80:83], v[160:163]
    ds_read_b128 v[68:71], v8 offset:56320
    v_mfma_f32_16x16x32_bf16 v[132:135], a[156:159], v[84:87], v[132:135]
    v_mfma_f32_16x16x32_bf16 v[148:151], a[160:163], v[84:87], v[148:151]
    buffer_load_dwordx4 v62, s[84:87], s35 offen offset:3072 sc1 lds
    v_mfma_f32_16x16x32_bf16 v[164:167], a[164:167], v[84:87], v[164:167]
    ds_read_b128 v[72:75], v9 offset:52224
    v_mfma_f32_16x16x32_bf16 v[136:139], a[156:159], v[88:91], v[136:139]
    v_mfma_f32_16x16x32_bf16 v[152:155], a[160:163], v[88:91], v[152:155]
    s_waitcnt vmcnt(20)
    ds_read_b64_tr_b16 a[224:225], v16 offset:0
    v_mfma_f32_16x16x32_bf16 v[168:171], a[164:167], v[88:91], v[168:171]
    ds_read_b64_tr_b16 a[226:227], v16 offset:512
    ds_read_b128 v[76:79], v9 offset:56320
    v_mfma_f32_16x16x32_bf16 v[140:143], a[156:159], v[92:95], v[140:143]
    ds_read_b64_tr_b16 a[228:229], v17 offset:0
    ds_read_b64_tr_b16 a[230:231], v17 offset:512
    v_mfma_f32_16x16x32_bf16 v[156:159], a[160:163], v[92:95], v[156:159]
    ds_read_b64_tr_b16 a[232:233], v18 offset:0
    ds_read_b64_tr_b16 a[234:235], v18 offset:512
    v_mfma_f32_16x16x32_bf16 v[172:175], a[164:167], v[92:95], v[172:175]
    ds_read_b64_tr_b16 a[236:237], v19 offset:0
    ds_read_b64_tr_b16 a[238:239], v19 offset:512
    s_waitcnt lgkmcnt(12)
    v_mfma_f32_16x16x32_bf16 v[128:131], a[168:171], v[96:99], v[128:131]
    s_add_u32 m0, s28, 32768
    s_add_u32 s35, s42, 131072
    v_mfma_f32_16x16x32_bf16 v[144:147], a[172:175], v[96:99], v[144:147]
    buffer_load_dwordx4 v12, s[68:71], s35 offen offset:0 lds
    v_mfma_f32_16x16x32_bf16 v[160:163], a[176:179], v[96:99], v[160:163]
    buffer_load_dwordx4 v13, s[68:71], s35 offen offset:1024 lds
    buffer_load_dwordx4 v14, s[68:71], s35 offen offset:2048 lds
    v_mfma_f32_16x16x32_bf16 v[132:135], a[168:171], v[100:103], v[132:135]
    buffer_load_dwordx4 v15, s[68:71], s35 offen offset:3072 lds
    v_add_f32_dpp v33, v33, v33 row_ror:8 row_mask:0xf bank_mask:0xf
    v_mfma_f32_16x16x32_bf16 v[148:151], a[172:175], v[100:103], v[148:151]
    v_add_f32_dpp v37, v37, v37 row_ror:8 row_mask:0xf bank_mask:0xf
    v_add_f32_dpp v41, v41, v41 row_ror:8 row_mask:0xf bank_mask:0xf
    v_mfma_f32_16x16x32_bf16 v[164:167], a[176:179], v[100:103], v[164:167]
    v_add_f32_dpp v45, v45, v45 row_ror:8 row_mask:0xf bank_mask:0xf
    v_add_f32_dpp v33, v33, v33 row_ror:4 row_mask:0xf bank_mask:0xf
    v_mfma_f32_16x16x32_bf16 v[136:139], a[168:171], v[104:107], v[136:139]
    v_add_f32_dpp v37, v37, v37 row_ror:4 row_mask:0xf bank_mask:0xf
    v_add_f32_dpp v41, v41, v41 row_ror:4 row_mask:0xf bank_mask:0xf
    v_mfma_f32_16x16x32_bf16 v[152:155], a[172:175], v[104:107], v[152:155]
    v_add_f32_dpp v45, v45, v45 row_ror:4 row_mask:0xf bank_mask:0xf
    v_add_f32_dpp v33, v33, v33 row_ror:2 row_mask:0xf bank_mask:0xf
    v_mfma_f32_16x16x32_bf16 v[168:171], a[176:179], v[104:107], v[168:171]
    v_add_f32_dpp v37, v37, v37 row_ror:2 row_mask:0xf bank_mask:0xf
    v_add_f32_dpp v41, v41, v41 row_ror:2 row_mask:0xf bank_mask:0xf
    v_mfma_f32_16x16x32_bf16 v[140:143], a[168:171], v[108:111], v[140:143]
    v_add_f32_dpp v45, v45, v45 row_ror:2 row_mask:0xf bank_mask:0xf
    v_add_f32_dpp v33, v33, v33 row_ror:1 row_mask:0xf bank_mask:0xf
    v_mfma_f32_16x16x32_bf16 v[156:159], a[172:175], v[108:111], v[156:159]
    v_add_f32_dpp v37, v37, v37 row_ror:1 row_mask:0xf bank_mask:0xf
    v_add_f32_dpp v41, v41, v41 row_ror:1 row_mask:0xf bank_mask:0xf
    v_mfma_f32_16x16x32_bf16 v[172:175], a[176:179], v[108:111], v[172:175]
    v_add_f32_dpp v45, v45, v45 row_ror:1 row_mask:0xf bank_mask:0xf
    s_waitcnt lgkmcnt(6)
    v_mfma_f32_16x16x32_bf16 v[128:131], a[180:183], v[64:67], v[128:131]
    v_mov_b32 v32, 0x3727c5ac
    v_mov_b32 v36, 0x3727c5ac
    v_mfma_f32_16x16x32_bf16 v[144:147], a[184:187], v[64:67], v[144:147]
    v_mov_b32 v40, 0x3727c5ac
    v_mov_b32 v44, 0x3727c5ac
    v_mfma_f32_16x16x32_bf16 v[160:163], a[188:191], v[64:67], v[160:163]
    v_fmac_f32 v32, 0x3b000000, v33
    v_fmac_f32 v36, 0x3b000000, v37
    v_mfma_f32_16x16x32_bf16 v[132:135], a[180:183], v[68:71], v[132:135]
    v_fmac_f32 v40, 0x3b000000, v41
    v_fmac_f32 v44, 0x3b000000, v45
    v_mfma_f32_16x16x32_bf16 v[148:151], a[184:187], v[68:71], v[148:151]
    v_rsq_f32 v32, v32
    v_rsq_f32 v36, v36
    v_mfma_f32_16x16x32_bf16 v[164:167], a[188:191], v[68:71], v[164:167]
    v_rsq_f32 v40, v40
    v_rsq_f32 v44, v44
    v_mfma_f32_16x16x32_bf16 v[136:139], a[180:183], v[72:75], v[136:139]
    v_mul_f32 v33, 0xbb000000, v34
    v_mul_f32 v37, 0xbb000000, v38
    v_mfma_f32_16x16x32_bf16 v[152:155], a[184:187], v[72:75], v[152:155]
    v_mul_f32 v41, 0xbb000000, v42
    v_mul_f32 v45, 0xbb000000, v46
    v_mfma_f32_16x16x32_bf16 v[168:171], a[188:191], v[72:75], v[168:171]
    v_mul_f32 v33, v33, v32
    v_mul_f32 v37, v37, v36
    v_mfma_f32_16x16x32_bf16 v[140:143], a[180:183], v[76:79], v[140:143]
    v_mul_f32 v41, v41, v40
    v_mul_f32 v45, v45, v44
    v_mfma_f32_16x16x32_bf16 v[156:159], a[184:187], v[76:79], v[156:159]
    ds_write_b64 v53, v[32:33] offset:0
    ds_write_b64 v53, v[36:37] offset:32
    v_mfma_f32_16x16x32_bf16 v[172:175], a[188:191], v[76:79], v[172:175]
    ds_write_b64 v53, v[40:41] offset:64
    ds_write_b64 v53, v[44:45] offset:96
    s_waitcnt lgkmcnt(0)
    s_barrier
    v_xor_b32 v63, 256, v56
    ds_read_b64 v[36:37], v63 offset:0
    ds_read_b64 v[38:39], v63 offset:128
    ds_read_b64 v[32:33], v56 offset:0
    ds_read_b64 v[34:35], v56 offset:128
    ds_read_b128 v[240:243], v57 offset:256
    ds_read_b128 v[244:247], v57 offset:320
    ds_read_b128 v[224:227], v57 offset:0
    ds_read_b128 v[228:231], v57 offset:64
    ds_read_b128 v[232:235], v57 offset:128
    ds_read_b128 v[236:239], v57 offset:192
    s_and_b32 s12, s5, 1
    s_mul_i32 s12, s12, 88064
    s_xor_b32 s13, s12, 88064
    s_waitcnt lgkmcnt(0)
    v_pk_fma_f32 v[40:41], v[240:241], v[36:37], v[244:245] op_sel:[0,1,0] op_sel_hi:[1,1,1]
    v_pk_fma_f32 v[168:169], v[168:169], v[36:37], v[40:41] op_sel_hi:[1,0,1]
    v_pk_fma_f32 v[42:43], v[242:243], v[36:37], v[246:247] op_sel:[0,1,0] op_sel_hi:[1,1,1]
    v_pk_fma_f32 v[170:171], v[170:171], v[36:37], v[42:43] op_sel_hi:[1,0,1]
    ds_write_b128 v58, v[168:171] offset:0
    v_pk_fma_f32 v[44:45], v[240:241], v[38:39], v[244:245] op_sel:[0,1,0] op_sel_hi:[1,1,1]
    v_pk_fma_f32 v[172:173], v[172:173], v[38:39], v[44:45] op_sel_hi:[1,0,1]
    v_pk_fma_f32 v[46:47], v[242:243], v[38:39], v[246:247] op_sel:[0,1,0] op_sel_hi:[1,1,1]
    v_pk_fma_f32 v[174:175], v[174:175], v[38:39], v[46:47] op_sel_hi:[1,0,1]
    ds_write_b128 v58, v[172:175] offset:1024
    v_pk_fma_f32 v[40:41], v[224:225], v[32:33], v[228:229] op_sel:[0,1,0] op_sel_hi:[1,1,1]
    v_pk_fma_f32 v[128:129], v[128:129], v[32:33], v[40:41] op_sel_hi:[1,0,1]
    v_pk_fma_f32 v[42:43], v[226:227], v[32:33], v[230:231] op_sel:[0,1,0] op_sel_hi:[1,1,1]
    v_pk_fma_f32 v[130:131], v[130:131], v[32:33], v[42:43] op_sel_hi:[1,0,1]
    v_pk_fma_f32 v[44:45], v[224:225], v[34:35], v[228:229] op_sel:[0,1,0] op_sel_hi:[1,1,1]
    v_pk_fma_f32 v[132:133], v[132:133], v[34:35], v[44:45] op_sel_hi:[1,0,1]
    v_pk_fma_f32 v[46:47], v[226:227], v[34:35], v[230:231] op_sel:[0,1,0] op_sel_hi:[1,1,1]
    v_pk_fma_f32 v[134:135], v[134:135], v[34:35], v[46:47] op_sel_hi:[1,0,1]
    v_pk_fma_f32 v[40:41], v[232:233], v[32:33], v[236:237] op_sel:[0,1,0] op_sel_hi:[1,1,1]
    v_pk_fma_f32 v[144:145], v[144:145], v[32:33], v[40:41] op_sel_hi:[1,0,1]
    v_pk_fma_f32 v[42:43], v[234:235], v[32:33], v[238:239] op_sel:[0,1,0] op_sel_hi:[1,1,1]
    v_pk_fma_f32 v[146:147], v[146:147], v[32:33], v[42:43] op_sel_hi:[1,0,1]
    v_pk_fma_f32 v[44:45], v[232:233], v[34:35], v[236:237] op_sel:[0,1,0] op_sel_hi:[1,1,1]
    v_pk_fma_f32 v[148:149], v[148:149], v[34:35], v[44:45] op_sel_hi:[1,0,1]
    v_pk_fma_f32 v[46:47], v[234:235], v[34:35], v[238:239] op_sel:[0,1,0] op_sel_hi:[1,1,1]
    v_pk_fma_f32 v[150:151], v[150:151], v[34:35], v[46:47] op_sel_hi:[1,0,1]
    v_pk_mul_f32 v[128:129], v[128:129], v[144:145]
    v_pk_mul_f32 v[130:131], v[130:131], v[146:147]
    v_cvt_pk_bf16_f32 v72, v128, v129
    v_cvt_pk_bf16_f32 v73, v130, v131
    v_pk_mul_f32 v[132:133], v[132:133], v[148:149]
    v_pk_mul_f32 v[134:135], v[134:135], v[150:151]
    v_cvt_pk_bf16_f32 v74, v132, v133
    v_cvt_pk_bf16_f32 v75, v134, v135
    s_add_u32 s11, s30, s12
    s_add_u32 s11, s11, 0
    v_permlane16_swap_b32 v72, v74
    v_permlane16_swap_b32 v73, v75
    buffer_store_dwordx4 v[72:75], v59, s[84:87], s11 offen sc1
    s_waitcnt lgkmcnt(0)
    s_barrier
    v_xor_b32 v63, 2048, v58
    ds_read_b128 v[168:171], v63 offset:0
    ds_read_b128 v[172:175], v63 offset:1024
    v_pk_fma_f32 v[40:41], v[224:225], v[36:37], v[228:229] op_sel:[0,1,0] op_sel_hi:[1,1,1]
    v_pk_fma_f32 v[136:137], v[136:137], v[36:37], v[40:41] op_sel_hi:[1,0,1]
    v_pk_fma_f32 v[42:43], v[226:227], v[36:37], v[230:231] op_sel:[0,1,0] op_sel_hi:[1,1,1]
    v_pk_fma_f32 v[138:139], v[138:139], v[36:37], v[42:43] op_sel_hi:[1,0,1]
    v_pk_fma_f32 v[44:45], v[224:225], v[38:39], v[228:229] op_sel:[0,1,0] op_sel_hi:[1,1,1]
    v_pk_fma_f32 v[140:141], v[140:141], v[38:39], v[44:45] op_sel_hi:[1,0,1]
    v_pk_fma_f32 v[46:47], v[226:227], v[38:39], v[230:231] op_sel:[0,1,0] op_sel_hi:[1,1,1]
    v_pk_fma_f32 v[142:143], v[142:143], v[38:39], v[46:47] op_sel_hi:[1,0,1]
    v_pk_fma_f32 v[40:41], v[232:233], v[36:37], v[236:237] op_sel:[0,1,0] op_sel_hi:[1,1,1]
    v_pk_fma_f32 v[152:153], v[152:153], v[36:37], v[40:41] op_sel_hi:[1,0,1]
    v_pk_fma_f32 v[42:43], v[234:235], v[36:37], v[238:239] op_sel:[0,1,0] op_sel_hi:[1,1,1]
    v_pk_fma_f32 v[154:155], v[154:155], v[36:37], v[42:43] op_sel_hi:[1,0,1]
    v_pk_fma_f32 v[44:45], v[232:233], v[38:39], v[236:237] op_sel:[0,1,0] op_sel_hi:[1,1,1]
    v_pk_fma_f32 v[156:157], v[156:157], v[38:39], v[44:45] op_sel_hi:[1,0,1]
    v_pk_fma_f32 v[46:47], v[234:235], v[38:39], v[238:239] op_sel:[0,1,0] op_sel_hi:[1,1,1]
    v_pk_fma_f32 v[158:159], v[158:159], v[38:39], v[46:47] op_sel_hi:[1,0,1]
    v_pk_mul_f32 v[136:137], v[136:137], v[152:153]
    v_pk_mul_f32 v[138:139], v[138:139], v[154:155]
    v_cvt_pk_bf16_f32 v76, v136, v137
    v_cvt_pk_bf16_f32 v77, v138, v139
    v_pk_mul_f32 v[140:141], v[140:141], v[156:157]
    v_pk_mul_f32 v[142:143], v[142:143], v[158:159]
    v_cvt_pk_bf16_f32 v78, v140, v141
    v_cvt_pk_bf16_f32 v79, v142, v143
    s_add_u32 s11, s30, s13
    s_add_u32 s11, s11, 0
    v_permlane16_swap_b32 v76, v78
    v_permlane16_swap_b32 v77, v79
    buffer_store_dwordx4 v[76:79], v59, s[84:87], s11 offen sc1
    v_pk_fma_f32 v[40:41], v[240:241], v[32:33], v[244:245] op_sel:[0,1,0] op_sel_hi:[1,1,1]
    v_pk_fma_f32 v[160:161], v[160:161], v[32:33], v[40:41] op_sel_hi:[1,0,1]
    v_pk_fma_f32 v[42:43], v[242:243], v[32:33], v[246:247] op_sel:[0,1,0] op_sel_hi:[1,1,1]
    v_pk_fma_f32 v[162:163], v[162:163], v[32:33], v[42:43] op_sel_hi:[1,0,1]
    v_pk_fma_f32 v[44:45], v[240:241], v[34:35], v[244:245] op_sel:[0,1,0] op_sel_hi:[1,1,1]
    v_pk_fma_f32 v[164:165], v[164:165], v[34:35], v[44:45] op_sel_hi:[1,0,1]
    v_pk_fma_f32 v[46:47], v[242:243], v[34:35], v[246:247] op_sel:[0,1,0] op_sel_hi:[1,1,1]
    v_pk_fma_f32 v[166:167], v[166:167], v[34:35], v[46:47] op_sel_hi:[1,0,1]
    s_waitcnt lgkmcnt(0)
    v_pk_mul_f32 v[160:161], v[160:161], v[168:169]
    v_pk_mul_f32 v[162:163], v[162:163], v[170:171]
    v_cvt_pk_bf16_f32 v128, v160, v161
    v_cvt_pk_bf16_f32 v129, v162, v163
    v_pk_mul_f32 v[164:165], v[164:165], v[172:173]
    v_pk_mul_f32 v[166:167], v[166:167], v[174:175]
    v_cvt_pk_bf16_f32 v130, v164, v165
    v_cvt_pk_bf16_f32 v131, v166, v167
    s_add_u32 s11, s34, s12
    s_add_u32 s11, s11, 0
    v_permlane16_swap_b32 v128, v130
    v_permlane16_swap_b32 v129, v131
    buffer_store_dwordx4 v[128:131], v59, s[84:87], s11 offen sc1
    s_waitcnt vmcnt(23)
    s_barrier
    ds_read_b128 v[64:67], v10 offset:0
    ds_read_b128 v[68:71], v10 offset:4096
    ds_read_b128 v[72:75], v11 offset:0
    ds_read_b128 v[76:79], v11 offset:4096
    ds_read_b128 v[80:83], v10 offset:1024
    ds_read_b128 v[84:87], v10 offset:5120
    ds_read_b128 v[88:91], v11 offset:1024
    ds_read_b128 v[92:95], v11 offset:5120
    ds_read_b128 v[96:99], v10 offset:2048
    s_waitcnt lgkmcnt(5)
    v_mfma_f32_16x16x32_bf16 v[176:179], a[0:3], v[64:67], 0
    s_add_u32 s14, s29, 16384
    buffer_load_dwordx4 v[32:35], v5, s[84:87], s14 offen offset:0 sc1
    v_mfma_f32_16x16x32_bf16 v[192:195], a[4:7], v[64:67], 0
    buffer_load_dwordx4 v[36:39], v5, s[84:87], s14 offen offset:1024 sc1
    buffer_load_dwordx4 v[40:43], v5, s[84:87], s14 offen offset:2048 sc1
    v_mfma_f32_16x16x32_bf16 v[208:211], a[8:11], v[64:67], 0
    buffer_load_dwordx4 v[44:47], v5, s[84:87], s14 offen offset:3072 sc1
    ds_read_b128 v[100:103], v10 offset:6144
    v_mfma_f32_16x16x32_bf16 v[180:183], a[0:3], v[68:71], 0
    s_add_u32 m0, s28, 0
    s_add_u32 s35, s42, 163840
    v_mfma_f32_16x16x32_bf16 v[196:199], a[4:7], v[68:71], 0
    buffer_load_dwordx4 v12, s[68:71], s35 offen offset:0 lds
    v_mfma_f32_16x16x32_bf16 v[212:215], a[8:11], v[68:71], 0
    ds_read_b128 v[104:107], v11 offset:2048
    v_mfma_f32_16x16x32_bf16 v[184:187], a[0:3], v[72:75], 0
    buffer_load_dwordx4 v13, s[68:71], s35 offen offset:1024 lds
    v_mfma_f32_16x16x32_bf16 v[200:203], a[4:7], v[72:75], 0
    v_mfma_f32_16x16x32_bf16 v[216:219], a[8:11], v[72:75], 0
    ds_read_b128 v[108:111], v11 offset:6144
    v_mfma_f32_16x16x32_bf16 v[188:191], a[0:3], v[76:79], 0
    v_mfma_f32_16x16x32_bf16 v[204:207], a[4:7], v[76:79], 0
    v_mfma_f32_16x16x32_bf16 v[220:223], a[8:11], v[76:79], 0
    ds_read_b128 v[64:67], v10 offset:3072
    s_waitcnt lgkmcnt(5)
    v_mfma_f32_16x16x32_bf16 v[176:179], a[12:15], v[80:83], v[176:179]
    buffer_load_dwordx4 v14, s[68:71], s35 offen offset:2048 lds
    v_mfma_f32_16x16x32_bf16 v[192:195], a[16:19], v[80:83], v[192:195]
    v_mfma_f32_16x16x32_bf16 v[208:211], a[20:23], v[80:83], v[208:211]
    ds_read_b128 v[68:71], v10 offset:7168
    v_mfma_f32_16x16x32_bf16 v[180:183], a[12:15], v[84:87], v[180:183]
    v_mfma_f32_16x16x32_bf16 v[196:199], a[16:19], v[84:87], v[196:199]
    buffer_load_dwordx4 v15, s[68:71], s35 offen offset:3072 lds
    v_mfma_f32_16x16x32_bf16 v[212:215], a[20:23], v[84:87], v[212:215]
    ds_read_b128 v[72:75], v11 offset:3072
    v_mfma_f32_16x16x32_bf16 v[184:187], a[12:15], v[88:91], v[184:187]
    v_mfma_f32_16x16x32_bf16 v[200:203], a[16:19], v[88:91], v[200:203]
    s_waitcnt vmcnt(19)
    ds_read_b64_tr_b16 a[240:241], v16 offset:16384
    v_mfma_f32_16x16x32_bf16 v[216:219], a[20:23], v[88:91], v[216:219]
    ds_read_b64_tr_b16 a[242:243], v16 offset:16896
    ds_read_b128 v[76:79], v11 offset:7168
    v_mfma_f32_16x16x32_bf16 v[188:191], a[12:15], v[92:95], v[188:191]
    ds_read_b64_tr_b16 a[244:245], v17 offset:16384
    ds_read_b64_tr_b16 a[246:247], v17 offset:16896
    v_mfma_f32_16x16x32_bf16 v[204:207], a[16:19], v[92:95], v[204:207]
    ds_read_b64_tr_b16 a[248:249], v18 offset:16384
    ds_read_b64_tr_b16 a[250:251], v18 offset:16896
    v_mfma_f32_16x16x32_bf16 v[220:223], a[20:23], v[92:95], v[220:223]
    ds_read_b64_tr_b16 a[252:253], v19 offset:16384
    ds_read_b64_tr_b16 a[254:255], v19 offset:16896
    s_barrier
    ds_read_b128 v[80:83], v10 offset:16384
    s_waitcnt lgkmcnt(13)
    v_mfma_f32_16x16x32_bf16 v[176:179], a[24:27], v[96:99], v[176:179]
    s_add_u32 m0, s28, 49152
    s_add_u32 s35, s42, 196608
    v_mfma_f32_16x16x32_bf16 v[192:195], a[28:31], v[96:99], v[192:195]
    buffer_load_dwordx4 v12, s[68:71], s35 offen offset:0 lds
    v_mfma_f32_16x16x32_bf16 v[208:211], a[32:35], v[96:99], v[208:211]
    ds_read_b128 v[84:87], v10 offset:20480
    v_mfma_f32_16x16x32_bf16 v[180:183], a[24:27], v[100:103], v[180:183]
    v_mfma_f32_16x16x32_bf16 v[196:199], a[28:31], v[100:103], v[196:199]
    v_mfma_f32_16x16x32_bf16 v[212:215], a[32:35], v[100:103], v[212:215]
    ds_read_b128 v[88:91], v11 offset:16384
    v_mfma_f32_16x16x32_bf16 v[184:187], a[24:27], v[104:107], v[184:187]
    buffer_load_dwordx4 v13, s[68:71], s35 offen offset:1024 lds
    v_mfma_f32_16x16x32_bf16 v[200:203], a[28:31], v[104:107], v[200:203]
    v_mfma_f32_16x16x32_bf16 v[216:219], a[32:35], v[104:107], v[216:219]
    ds_read_b128 v[92:95], v11 offset:20480
    v_mfma_f32_16x16x32_bf16 v[188:191], a[24:27], v[108:111], v[188:191]
    v_mfma_f32_16x16x32_bf16 v[204:207], a[28:31], v[108:111], v[204:207]
    v_mfma_f32_16x16x32_bf16 v[220:223], a[32:35], v[108:111], v[220:223]
    ds_read_b128 v[96:99], v10 offset:17408
    s_waitcnt lgkmcnt(11)
    v_mfma_f32_16x16x32_bf16 v[176:179], a[36:39], v[64:67], v[176:179]
    buffer_load_dwordx4 v14, s[68:71], s35 offen offset:2048 lds
    v_mfma_f32_16x16x32_bf16 v[192:195], a[40:43], v[64:67], v[192:195]
    v_mfma_f32_16x16x32_bf16 v[208:211], a[44:47], v[64:67], v[208:211]
    ds_read_b128 v[100:103], v10 offset:21504
    v_mfma_f32_16x16x32_bf16 v[180:183], a[36:39], v[68:71], v[180:183]
    v_mfma_f32_16x16x32_bf16 v[196:199], a[40:43], v[68:71], v[196:199]
    v_mfma_f32_16x16x32_bf16 v[212:215], a[44:47], v[68:71], v[212:215]
    ds_read_b128 v[104:107], v11 offset:17408
    v_mfma_f32_16x16x32_bf16 v[184:187], a[36:39], v[72:75], v[184:187]
    buffer_load_dwordx4 v15, s[68:71], s35 offen offset:3072 lds
    v_mfma_f32_16x16x32_bf16 v[200:203], a[40:43], v[72:75], v[200:203]
    v_mfma_f32_16x16x32_bf16 v[216:219], a[44:47], v[72:75], v[216:219]
    ds_read_b128 v[108:111], v11 offset:21504
    v_mfma_f32_16x16x32_bf16 v[188:191], a[36:39], v[76:79], v[188:191]
    v_mfma_f32_16x16x32_bf16 v[204:207], a[40:43], v[76:79], v[204:207]
    v_mfma_f32_16x16x32_bf16 v[220:223], a[44:47], v[76:79], v[220:223]
    s_lshl_b32 s11, s38, 4
    s_add_u32 s11, s11, s39
    s_lshl_b32 s11, s11, 7
    s_add_u32 s11, s11, 589824
    s_waitcnt vmcnt(12)
    s_barrier
    buffer_store_dword v4, v23, s[84:87], s11 offen sc1
    s_barrier
    ds_read_b128 v[64:67], v10 offset:18432
    s_waitcnt lgkmcnt(5)
    v_mfma_f32_16x16x32_bf16 v[176:179], a[48:51], v[80:83], v[176:179]
    s_add_u32 m0, s28, 16384
    v_mfma_f32_16x16x32_bf16 v[192:195], a[52:55], v[80:83], v[192:195]
    s_add_u32 s35, s42, 229376
    buffer_load_dwordx4 v12, s[68:71], s35 offen offset:0 lds
    v_mfma_f32_16x16x32_bf16 v[208:211], a[56:59], v[80:83], v[208:211]
    ds_read_b128 v[68:71], v10 offset:22528
    v_mfma_f32_16x16x32_bf16 v[180:183], a[48:51], v[84:87], v[180:183]
    v_mfma_f32_16x16x32_bf16 v[196:199], a[52:55], v[84:87], v[196:199]
    v_mfma_f32_16x16x32_bf16 v[212:215], a[56:59], v[84:87], v[212:215]
    ds_read_b128 v[72:75], v11 offset:18432
    v_mfma_f32_16x16x32_bf16 v[184:187], a[48:51], v[88:91], v[184:187]
    buffer_load_dwordx4 v13, s[68:71], s35 offen offset:1024 lds
    v_mfma_f32_16x16x32_bf16 v[200:203], a[52:55], v[88:91], v[200:203]
    v_mfma_f32_16x16x32_bf16 v[216:219], a[56:59], v[88:91], v[216:219]
    ds_read_b128 v[76:79], v11 offset:22528
    v_mfma_f32_16x16x32_bf16 v[188:191], a[48:51], v[92:95], v[188:191]
    v_mfma_f32_16x16x32_bf16 v[204:207], a[52:55], v[92:95], v[204:207]
    v_mfma_f32_16x16x32_bf16 v[220:223], a[56:59], v[92:95], v[220:223]
    ds_read_b128 v[80:83], v10 offset:19456
    s_waitcnt lgkmcnt(5)
    v_mfma_f32_16x16x32_bf16 v[176:179], a[60:63], v[96:99], v[176:179]
    buffer_load_dwordx4 v14, s[68:71], s35 offen offset:2048 lds
    v_mfma_f32_16x16x32_bf16 v[192:195], a[64:67], v[96:99], v[192:195]
    v_mfma_f32_16x16x32_bf16 v[208:211], a[68:71], v[96:99], v[208:211]
    ds_read_b128 v[84:87], v10 offset:23552
    v_mfma_f32_16x16x32_bf16 v[180:183], a[60:63], v[100:103], v[180:183]
    v_mfma_f32_16x16x32_bf16 v[196:199], a[64:67], v[100:103], v[196:199]
    v_mfma_f32_16x16x32_bf16 v[212:215], a[68:71], v[100:103], v[212:215]
    ds_read_b128 v[88:91], v11 offset:19456
    v_mfma_f32_16x16x32_bf16 v[184:187], a[60:63], v[104:107], v[184:187]
    buffer_load_dwordx4 v15, s[68:71], s35 offen offset:3072 lds
    v_mfma_f32_16x16x32_bf16 v[200:203], a[64:67], v[104:107], v[200:203]
    v_mfma_f32_16x16x32_bf16 v[216:219], a[68:71], v[104:107], v[216:219]
    ds_read_b128 v[92:95], v11 offset:23552
    v_mfma_f32_16x16x32_bf16 v[188:191], a[60:63], v[108:111], v[188:191]
    v_mfma_f32_16x16x32_bf16 v[204:207], a[64:67], v[108:111], v[204:207]
    v_mfma_f32_16x16x32_bf16 v[220:223], a[68:71], v[108:111], v[220:223]
    s_barrier
    ds_read_b128 v[96:99], v10 offset:32768
    s_waitcnt lgkmcnt(5)
    v_mfma_f32_16x16x32_bf16 v[176:179], a[72:75], v[64:67], v[176:179]
    s_add_u32 m0, s28, 65536
    s_add_u32 s35, s42, 262144
    v_mfma_f32_16x16x32_bf16 v[192:195], a[76:79], v[64:67], v[192:195]
    buffer_load_dwordx4 v12, s[68:71], s35 offen offset:0 lds
    v_mfma_f32_16x16x32_bf16 v[208:211], a[80:83], v[64:67], v[208:211]
    ds_read_b128 v[100:103], v10 offset:36864
    v_mfma_f32_16x16x32_bf16 v[180:183], a[72:75], v[68:71], v[180:183]
    v_mfma_f32_16x16x32_bf16 v[196:199], a[76:79], v[68:71], v[196:199]
    v_mfma_f32_16x16x32_bf16 v[212:215], a[80:83], v[68:71], v[212:215]
    ds_read_b128 v[104:107], v11 offset:32768
    v_mfma_f32_16x16x32_bf16 v[184:187], a[72:75], v[72:75], v[184:187]
    buffer_load_dwordx4 v13, s[68:71], s35 offen offset:1024 lds
    v_mfma_f32_16x16x32_bf16 v[200:203], a[76:79], v[72:75], v[200:203]
    v_mfma_f32_16x16x32_bf16 v[216:219], a[80:83], v[72:75], v[216:219]
    ds_read_b128 v[108:111], v11 offset:36864
    v_mfma_f32_16x16x32_bf16 v[188:191], a[72:75], v[76:79], v[188:191]
    v_mfma_f32_16x16x32_bf16 v[204:207], a[76:79], v[76:79], v[204:207]
    v_mfma_f32_16x16x32_bf16 v[220:223], a[80:83], v[76:79], v[220:223]
    ds_read_b128 v[64:67], v10 offset:33792
    s_waitcnt lgkmcnt(5)
    v_mfma_f32_16x16x32_bf16 v[176:179], a[84:87], v[80:83], v[176:179]
    buffer_load_dwordx4 v14, s[68:71], s35 offen offset:2048 lds
    v_mfma_f32_16x16x32_bf16 v[192:195], a[88:91], v[80:83], v[192:195]
    v_mfma_f32_16x16x32_bf16 v[208:211], a[92:95], v[80:83], v[208:211]
    ds_read_b128 v[68:71], v10 offset:37888
    v_mfma_f32_16x16x32_bf16 v[180:183], a[84:87], v[84:87], v[180:183]
    v_mfma_f32_16x16x32_bf16 v[196:199], a[88:91], v[84:87], v[196:199]
    v_mfma_f32_16x16x32_bf16 v[212:215], a[92:95], v[84:87], v[212:215]
    ds_read_b128 v[72:75], v11 offset:33792
    v_mfma_f32_16x16x32_bf16 v[184:187], a[84:87], v[88:91], v[184:187]
    buffer_load_dwordx4 v15, s[68:71], s35 offen offset:3072 lds
    v_mfma_f32_16x16x32_bf16 v[200:203], a[88:91], v[88:91], v[200:203]
    v_mfma_f32_16x16x32_bf16 v[216:219], a[92:95], v[88:91], v[216:219]
    ds_read_b128 v[76:79], v11 offset:37888
    v_mfma_f32_16x16x32_bf16 v[188:191], a[84:87], v[92:95], v[188:191]
    v_mfma_f32_16x16x32_bf16 v[204:207], a[88:91], v[92:95], v[204:207]
    v_mfma_f32_16x16x32_bf16 v[220:223], a[92:95], v[92:95], v[220:223]
    s_waitcnt vmcnt(17)
    v_xor_b32 v6, v34, v4
    v_bitop3_b32 v6, v6, v38, v4 bitop3:0xf6
    v_bitop3_b32 v6, v6, v42, v4 bitop3:0xf6
    v_bitop3_b32 v6, v6, v46, v4 bitop3:0xf6
    v_cmp_ne_u32 vcc, 0, v6
    s_cbranch_vccz Ldone_18
    s_mov_b32 s15, 0
    s_nop 3
Lspin_17:
    s_add_u32 s14, s29, 16384
    buffer_load_dwordx4 v[32:35], v5, s[84:87], s14 offen offset:0 sc1
    buffer_load_dwordx4 v[36:39], v5, s[84:87], s14 offen offset:1024 sc1
    buffer_load_dwordx4 v[40:43], v5, s[84:87], s14 offen offset:2048 sc1
    buffer_load_dwordx4 v[44:47], v5, s[84:87], s14 offen offset:3072 sc1
    s_waitcnt vmcnt(0)
    v_xor_b32 v6, v34, v4
    v_bitop3_b32 v6, v6, v38, v4 bitop3:0xf6
    v_bitop3_b32 v6, v6, v42, v4 bitop3:0xf6
    v_bitop3_b32 v6, v6, v46, v4 bitop3:0xf6
    v_cmp_ne_u32 vcc, 0, v6
    s_cbranch_vccz Ldone_18
    s_add_u32 s15, s15, 1
    s_cmp_lt_u32 s15, 400000
    s_cbranch_scc1 Lspin_17
Ldone_18:
    s_nop 1
    s_barrier
    ds_read_b128 v[80:83], v10 offset:34816
    s_waitcnt lgkmcnt(5)
    v_mfma_f32_16x16x32_bf16 v[176:179], a[96:99], v[96:99], v[176:179]
    s_add_u32 m0, s28, 81920
    s_add_u32 s35, s42, 294912
    v_mfma_f32_16x16x32_bf16 v[192:195], a[100:103], v[96:99], v[192:195]
    buffer_load_dwordx4 v12, s[68:71], s35 offen offset:0 lds
    v_mfma_f32_16x16x32_bf16 v[208:211], a[104:107], v[96:99], v[208:211]
    ds_read_b128 v[84:87], v10 offset:38912
    v_mfma_f32_16x16x32_bf16 v[180:183], a[96:99], v[100:103], v[180:183]
    buffer_load_dwordx4 v13, s[68:71], s35 offen offset:1024 lds
    buffer_load_dwordx4 v14, s[68:71], s35 offen offset:2048 lds
    v_mfma_f32_16x16x32_bf16 v[196:199], a[100:103], v[100:103], v[196:199]
    buffer_load_dwordx4 v15, s[68:71], s35 offen offset:3072 lds
    v_mov_b32 v34, v32
    v_mfma_f32_16x16x32_bf16 v[212:215], a[104:107], v[100:103], v[212:215]
    v_mov_b32 v38, v36
    ds_read_b128 v[88:91], v11 offset:34816
    v_mfma_f32_16x16x32_bf16 v[184:187], a[96:99], v[104:107], v[184:187]
    v_mov_b32 v42, v40
    v_mov_b32 v46, v44
    v_mfma_f32_16x16x32_bf16 v[200:203], a[100:103], v[104:107], v[200:203]
    v_add_f32_dpp v34, v34, v34 row_ror:8 row_mask:0xf bank_mask:0xf
    v_add_f32_dpp v38, v38, v38 row_ror:8 row_mask:0xf bank_mask:0xf
    v_mfma_f32_16x16x32_bf16 v[216:219], a[104:107], v[104:107], v[216:219]
    v_add_f32_dpp v42, v42, v42 row_ror:8 row_mask:0xf bank_mask:0xf
    ds_read_b128 v[92:95], v11 offset:38912
    v_mfma_f32_16x16x32_bf16 v[188:191], a[96:99], v[108:111], v[188:191]
    v_add_f32_dpp v46, v46, v46 row_ror:8 row_mask:0xf bank_mask:0xf
    v_add_f32_dpp v34, v34, v34 row_ror:4 row_mask:0xf bank_mask:0xf
    v_mfma_f32_16x16x32_bf16 v[204:207], a[100:103], v[108:111], v[204:207]
    v_add_f32_dpp v38, v38, v38 row_ror:4 row_mask:0xf bank_mask:0xf
    v_add_f32_dpp v42, v42, v42 row_ror:4 row_mask:0xf bank_mask:0xf
    v_mfma_f32_16x16x32_bf16 v[220:223], a[104:107], v[108:111], v[220:223]
    ds_read_b128 v[96:99], v10 offset:35840
    s_waitcnt lgkmcnt(5)
    v_mfma_f32_16x16x32_bf16 v[176:179], a[108:111], v[64:67], v[176:179]
    v_add_f32_dpp v46, v46, v46 row_ror:4 row_mask:0xf bank_mask:0xf
    v_add_f32_dpp v34, v34, v34 row_ror:2 row_mask:0xf bank_mask:0xf
    v_mfma_f32_16x16x32_bf16 v[192:195], a[112:115], v[64:67], v[192:195]
    v_add_f32_dpp v38, v38, v38 row_ror:2 row_mask:0xf bank_mask:0xf
    v_add_f32_dpp v42, v42, v42 row_ror:2 row_mask:0xf bank_mask:0xf
    v_mfma_f32_16x16x32_bf16 v[208:211], a[116:119], v[64:67], v[208:211]
    v_add_f32_dpp v46, v46, v46 row_ror:2 row_mask:0xf bank_mask:0xf
    ds_read_b128 v[100:103], v10 offset:39936
    v_mfma_f32_16x16x32_bf16 v[180:183], a[108:111], v[68:71], v[180:183]
    v_add_f32_dpp v34, v34, v34 row_ror:1 row_mask:0xf bank_mask:0xf
    v_add_f32_dpp v38, v38, v38 row_ror:1 row_mask:0xf bank_mask:0xf
    v_mfma_f32_16x16x32_bf16 v[196:199], a[112:115], v[68:71], v[196:199]
    v_add_f32_dpp v42, v42, v42 row_ror:1 row_mask:0xf bank_mask:0xf
    v_add_f32_dpp v46, v46, v46 row_ror:1 row_mask:0xf bank_mask:0xf
    v_mfma_f32_16x16x32_bf16 v[212:215], a[116:119], v[68:71], v[212:215]
    v_fmac_f32 v32, 0xbd800000, v34
    ds_read_b128 v[104:107], v11 offset:35840
    v_mfma_f32_16x16x32_bf16 v[184:187], a[108:111], v[72:75], v[184:187]
    v_fmac_f32 v36, 0xbd800000, v38
    v_fmac_f32 v40, 0xbd800000, v42
    v_mfma_f32_16x16x32_bf16 v[200:203], a[112:115], v[72:75], v[200:203]
    v_fmac_f32 v44, 0xbd800000, v46
    v_mul_f32 v32, v32, v32
    v_mfma_f32_16x16x32_bf16 v[216:219], a[116:119], v[72:75], v[216:219]
    v_mul_f32 v36, v36, v36
    ds_read_b128 v[108:111], v11 offset:39936
    v_mfma_f32_16x16x32_bf16 v[188:191], a[108:111], v[76:79], v[188:191]
    v_mul_f32 v40, v40, v40
    v_mul_f32 v44, v44, v44
    v_mfma_f32_16x16x32_bf16 v[204:207], a[112:115], v[76:79], v[204:207]
    v_fmac_f32 v33, 0x3d000000, v32
    v_fmac_f32 v37, 0x3d000000, v36
    v_mfma_f32_16x16x32_bf16 v[220:223], a[116:119], v[76:79], v[220:223]
    v_fmac_f32 v41, 0x3d000000, v40
    v_fmac_f32 v45, 0x3d000000, v44
    s_barrier
    ds_read_b128 v[64:67], v10 offset:49152
    s_waitcnt lgkmcnt(5)
    v_mfma_f32_16x16x32_bf16 v[176:179], a[120:123], v[80:83], v[176:179]
    s_lshl_b32 s11, s36, 11
    s_add_u32 s11, s11, 589824
    v_lshlrev_b32 v60, 7, v3
    v_mfma_f32_16x16x32_bf16 v[192:195], a[124:127], v[80:83], v[192:195]
    v_add_u32 v60, s11, v60
    s_lshr_b32 s11, s37, 3
    s_lshl_b32 s11, s11, 1
    v_mfma_f32_16x16x32_bf16 v[208:211], a[128:131], v[80:83], v[208:211]
    s_and_b32 s13, s5, 1
    s_add_u32 s11, s11, s13
    ds_read_b128 v[68:71], v10 offset:53248
    v_mfma_f32_16x16x32_bf16 v[180:183], a[120:123], v[84:87], v[180:183]
    s_mul_i32 s76, s11, 44032
    s_xor_b32 s11, s11, 1
    s_mul_i32 s77, s11, 44032
    v_mfma_f32_16x16x32_bf16 v[196:199], a[124:127], v[84:87], v[196:199]
    s_add_u32 s78, s76, 176128
    s_add_u32 s79, s77, 176128
    s_mul_i32 s11, s36, 352256
    v_mfma_f32_16x16x32_bf16 v[212:215], a[128:131], v[84:87], v[212:215]
    s_mul_i32 s12, s5, 11264
    s_add_u32 s11, s11, s12
    ds_read_b128 v[72:75], v11 offset:49152
    v_mfma_f32_16x16x32_bf16 v[184:187], a[120:123], v[88:91], v[184:187]
    s_add_u32 s11, s11, 10485760
    v_add_u32 v248, s11, v5
    v_add_u32 v249, 4096, v248
    v_mfma_f32_16x16x32_bf16 v[200:203], a[124:127], v[88:91], v[200:203]
    v_add_u32 v250, 8192, v248
    s_cmp_eq_u32 s5, 3
    s_cselect_b32 s11, 1024, 0
    v_mfma_f32_16x16x32_bf16 v[216:219], a[128:131], v[88:91], v[216:219]
    v_subrev_u32 v251, s11, v250
    buffer_load_dword v61, v60, s[84:87], 0 offen sc1
    ds_read_b128 v[76:79], v11 offset:53248
    v_mfma_f32_16x16x32_bf16 v[188:191], a[120:123], v[92:95], v[188:191]
    v_add_f32_dpp v33, v33, v33 row_ror:8 row_mask:0xf bank_mask:0xf
    v_add_f32_dpp v37, v37, v37 row_ror:8 row_mask:0xf bank_mask:0xf
    v_add_f32_dpp v41, v41, v41 row_ror:8 row_mask:0xf bank_mask:0xf
    v_mfma_f32_16x16x32_bf16 v[204:207], a[124:127], v[92:95], v[204:207]
    v_add_f32_dpp v45, v45, v45 row_ror:8 row_mask:0xf bank_mask:0xf
    v_add_f32_dpp v33, v33, v33 row_ror:4 row_mask:0xf bank_mask:0xf
    v_add_f32_dpp v37, v37, v37 row_ror:4 row_mask:0xf bank_mask:0xf
    v_mfma_f32_16x16x32_bf16 v[220:223], a[128:131], v[92:95], v[220:223]
    v_add_f32_dpp v41, v41, v41 row_ror:4 row_mask:0xf bank_mask:0xf
    ds_read_b128 v[80:83], v10 offset:50176
    s_waitcnt lgkmcnt(5)
    v_mfma_f32_16x16x32_bf16 v[176:179], a[132:135], v[96:99], v[176:179]
    v_add_f32_dpp v45, v45, v45 row_ror:4 row_mask:0xf bank_mask:0xf
    v_add_f32_dpp v33, v33, v33 row_ror:2 row_mask:0xf bank_mask:0xf
    v_add_f32_dpp v37, v37, v37 row_ror:2 row_mask:0xf bank_mask:0xf
    v_mfma_f32_16x16x32_bf16 v[192:195], a[136:139], v[96:99], v[192:195]
    v_add_f32_dpp v41, v41, v41 row_ror:2 row_mask:0xf bank_mask:0xf
    v_add_f32_dpp v45, v45, v45 row_ror:2 row_mask:0xf bank_mask:0xf
    v_add_f32_dpp v33, v33, v33 row_ror:1 row_mask:0xf bank_mask:0xf
    v_mfma_f32_16x16x32_bf16 v[208:211], a[140:143], v[96:99], v[208:211]
    v_add_f32_dpp v37, v37, v37 row_ror:1 row_mask:0xf bank_mask:0xf
    v_add_f32_dpp v41, v41, v41 row_ror:1 row_mask:0xf bank_mask:0xf
    ds_read_b128 v[84:87], v10 offset:54272
    v_mfma_f32_16x16x32_bf16 v[180:183], a[132:135], v[100:103], v[180:183]
    v_add_f32_dpp v45, v45, v45 row_ror:1 row_mask:0xf bank_mask:0xf
    v_mov_b32 v32, 0x3727c5ac
    v_mov_b32 v36, 0x3727c5ac
    v_mfma_f32_16x16x32_bf16 v[196:199], a[136:139], v[100:103], v[196:199]
    v_mov_b32 v40, 0x3727c5ac
    v_mov_b32 v44, 0x3727c5ac
    v_fmac_f32 v32, 0x3b000000, v33
    v_mfma_f32_16x16x32_bf16 v[212:215], a[140:143], v[100:103], v[212:215]
    v_fmac_f32 v36, 0x3b000000, v37
    v_fmac_f32 v40, 0x3b000000, v41
    ds_read_b128 v[88:91], v11 offset:50176
    v_mfma_f32_16x16x32_bf16 v[184:187], a[132:135], v[104:107], v[184:187]
    v_fmac_f32 v44, 0x3b000000, v45
    v_rsq_f32 v32, v32
    v_rsq_f32 v36, v36
    v_mfma_f32_16x16x32_bf16 v[200:203], a[136:139], v[104:107], v[200:203]
    v_rsq_f32 v40, v40
    v_rsq_f32 v44, v44
    v_mul_f32 v33, 0xbb000000, v34
    v_mfma_f32_16x16x32_bf16 v[216:219], a[140:143], v[104:107], v[216:219]
    v_mul_f32 v37, 0xbb000000, v38
    v_mul_f32 v41, 0xbb000000, v42
    ds_read_b128 v[92:95], v11 offset:54272
    v_mfma_f32_16x16x32_bf16 v[188:191], a[132:135], v[108:111], v[188:191]
    v_mul_f32 v45, 0xbb000000, v46
    v_mul_f32 v33, v33, v32
    v_mul_f32 v37, v37, v36
    v_mfma_f32_16x16x32_bf16 v[204:207], a[136:139], v[108:111], v[204:207]
    v_mul_f32 v41, v41, v40
    v_mul_f32 v45, v45, v44
    ds_write_b64 v53, v[32:33] offset:512
    v_mfma_f32_16x16x32_bf16 v[220:223], a[140:143], v[108:111], v[220:223]
    ds_write_b64 v53, v[36:37] offset:544
    ds_write_b64 v53, v[40:41] offset:576
    ds_write_b64 v53, v[44:45] offset:608
    s_barrier
    ds_read_b128 v[96:99], v10 offset:51200
    s_waitcnt lgkmcnt(9)
    v_mfma_f32_16x16x32_bf16 v[176:179], a[144:147], v[64:67], v[176:179]
    s_add_u32 m0, s28, 98304
    s_add_u32 s35, s42, 327680
    v_mfma_f32_16x16x32_bf16 v[192:195], a[148:151], v[64:67], v[192:195]
    buffer_load_dwordx4 v12, s[68:71], s35 offen offset:0 lds
    v_mfma_f32_16x16x32_bf16 v[208:211], a[152:155], v[64:67], v[208:211]
    ds_read_b128 v[100:103], v10 offset:55296
    v_mfma_f32_16x16x32_bf16 v[180:183], a[144:147], v[68:71], v[180:183]
    v_mfma_f32_16x16x32_bf16 v[196:199], a[148:151], v[68:71], v[196:199]
    v_mfma_f32_16x16x32_bf16 v[212:215], a[152:155], v[68:71], v[212:215]
    ds_read_b128 v[104:107], v11 offset:51200
    v_mfma_f32_16x16x32_bf16 v[184:187], a[144:147], v[72:75], v[184:187]
    buffer_load_dwordx4 v13, s[68:71], s35 offen offset:1024 lds
    v_mfma_f32_16x16x32_bf16 v[200:203], a[148:151], v[72:75], v[200:203]
    v_mfma_f32_16x16x32_bf16 v[216:219], a[152:155], v[72:75], v[216:219]
    ds_read_b128 v[108:111], v11 offset:55296
    v_mfma_f32_16x16x32_bf16 v[188:191], a[144:147], v[76:79], v[188:191]
    v_mfma_f32_16x16x32_bf16 v[204:207], a[148:151], v[76:79], v[204:207]
    v_mfma_f32_16x16x32_bf16 v[220:223], a[152:155], v[76:79], v[220:223]
    ds_read_b128 v[64:67], v10 offset:52224
    s_waitcnt lgkmcnt(9)
    v_mfma_f32_16x16x32_bf16 v[176:179], a[156:159], v[80:83], v[176:179]
    buffer_load_dwordx4 v14, s[68:71], s35 offen offset:2048 lds
    v_mfma_f32_16x16x32_bf16 v[192:195], a[160:163], v[80:83], v[192:195]
    v_mfma_f32_16x16x32_bf16 v[208:211], a[164:167], v[80:83], v[208:211]
    ds_read_b128 v[68:71], v10 offset:56320
    v_mfma_f32_16x16x32_bf16 v[180:183], a[156:159], v[84:87], v[180:183]
    v_mfma_f32_16x16x32_bf16 v[196:199], a[160:163], v[84:87], v[196:199]
    v_mfma_f32_16x16x32_bf16 v[212:215], a[164:167], v[84:87], v[212:215]
    ds_read_b128 v[72:75], v11 offset:52224
    v_mfma_f32_16x16x32_bf16 v[184:187], a[156:159], v[88:91], v[184:187]
    buffer_load_dwordx4 v15, s[68:71], s35 offen offset:3072 lds
    v_mfma_f32_16x16x32_bf16 v[200:203], a[160:163], v[88:91], v[200:203]
    v_mfma_f32_16x16x32_bf16 v[216:219], a[164:167], v[88:91], v[216:219]
    ds_read_b128 v[76:79], v11 offset:56320
    v_mfma_f32_16x16x32_bf16 v[188:191], a[156:159], v[92:95], v[188:191]
    v_mfma_f32_16x16x32_bf16 v[204:207], a[160:163], v[92:95], v[204:207]
    v_mfma_f32_16x16x32_bf16 v[220:223], a[164:167], v[92:95], v[220:223]
    s_waitcnt vmcnt(4)
    v_cmp_ne_u32 vcc, v61, v4
    s_cbranch_vccz Ldone_20
    s_mov_b32 s15, 0
    s_nop 3
Lspin_19:
    buffer_load_dword v61, v60, s[84:87], 0 offen sc1
    s_waitcnt vmcnt(0)
    v_cmp_ne_u32 vcc, v61, v4
    s_cbranch_vccz Ldone_20
    s_add_u32 s15, s15, 1
    s_cmp_lt_u32 s15, 400000
    s_cbranch_scc1 Lspin_19
Ldone_20:
    s_nop 1
    s_waitcnt lgkmcnt(4)
    v_mfma_f32_16x16x32_bf16 v[176:179], a[168:171], v[96:99], v[176:179]
    buffer_load_dwordx4 v[112:115], v248, s[84:87], s76 offen offset:0 sc1
    v_mfma_f32_16x16x32_bf16 v[192:195], a[172:175], v[96:99], v[192:195]
    v_mfma_f32_16x16x32_bf16 v[208:211], a[176:179], v[96:99], v[208:211]
    v_mfma_f32_16x16x32_bf16 v[180:183], a[168:171], v[100:103], v[180:183]
    buffer_load_dwordx4 v[116:119], v248, s[84:87], s77 offen offset:0 sc1
    v_mfma_f32_16x16x32_bf16 v[196:199], a[172:175], v[100:103], v[196:199]
    v_mfma_f32_16x16x32_bf16 v[212:215], a[176:179], v[100:103], v[212:215]
    v_mfma_f32_16x16x32_bf16 v[184:187], a[168:171], v[104:107], v[184:187]
    buffer_load_dwordx4 v[120:123], v248, s[84:87], s76 offen offset:1024 sc1
    v_mfma_f32_16x16x32_bf16 v[200:203], a[172:175], v[104:107], v[200:203]
    v_mfma_f32_16x16x32_bf16 v[216:219], a[176:179], v[104:107], v[216:219]
    v_mfma_f32_16x16x32_bf16 v[188:191], a[168:171], v[108:111], v[188:191]
    buffer_load_dwordx4 v[124:127], v248, s[84:87], s77 offen offset:1024 sc1
    v_mfma_f32_16x16x32_bf16 v[204:207], a[172:175], v[108:111], v[204:207]
    v_mfma_f32_16x16x32_bf16 v[220:223], a[176:179], v[108:111], v[220:223]
    s_waitcnt lgkmcnt(0)
    v_mfma_f32_16x16x32_bf16 v[176:179], a[180:183], v[64:67], v[176:179]
    buffer_load_dwordx4 v[128:131], v248, s[84:87], s76 offen offset:2048 sc1
    v_mfma_f32_16x16x32_bf16 v[192:195], a[184:187], v[64:67], v[192:195]
    v_mfma_f32_16x16x32_bf16 v[208:211], a[188:191], v[64:67], v[208:211]
    v_mfma_f32_16x16x32_bf16 v[180:183], a[180:183], v[68:71], v[180:183]
    buffer_load_dwordx4 v[132:135], v248, s[84:87], s77 offen offset:2048 sc1
    v_mfma_f32_16x16x32_bf16 v[196:199], a[184:187], v[68:71], v[196:199]
    v_mfma_f32_16x16x32_bf16 v[212:215], a[188:191], v[68:71], v[212:215]
    v_mfma_f32_16x16x32_bf16 v[184:187], a[180:183], v[72:75], v[184:187]
    buffer_load_dwordx4 v[136:139], v248, s[84:87], s76 offen offset:3072 sc1
    v_mfma_f32_16x16x32_bf16 v[200:203], a[184:187], v[72:75], v[200:203]
    v_mfma_f32_16x16x32_bf16 v[216:219], a[188:191], v[72:75], v[216:219]
    v_mfma_f32_16x16x32_bf16 v[188:191], a[180:183], v[76:79], v[188:191]
    buffer_load_dwordx4 v[140:143], v248, s[84:87], s77 offen offset:3072 sc1
    v_mfma_f32_16x16x32_bf16 v[204:207], a[184:187], v[76:79], v[204:207]
    v_mfma_f32_16x16x32_bf16 v[220:223], a[188:191], v[76:79], v[220:223]
    s_barrier
    v_xor_b32 v63, 256, v56
    ds_read_b64 v[36:37], v63 offset:512
    ds_read_b64 v[38:39], v63 offset:640
    ds_read_b64 v[32:33], v56 offset:512
    ds_read_b64 v[34:35], v56 offset:640
    s_and_b32 s12, s5, 1
    s_mul_i32 s12, s12, 88064
    s_xor_b32 s13, s12, 88064
    s_waitcnt lgkmcnt(0)
    v_pk_fma_f32 v[40:41], v[240:241], v[36:37], v[244:245] op_sel:[0,1,0] op_sel_hi:[1,1,1]
    buffer_load_dwordx4 v[144:147], v249, s[84:87], s76 offen offset:0 sc1
    v_pk_fma_f32 v[216:217], v[216:217], v[36:37], v[40:41] op_sel_hi:[1,0,1]
    v_pk_fma_f32 v[42:43], v[242:243], v[36:37], v[246:247] op_sel:[0,1,0] op_sel_hi:[1,1,1]
    v_pk_fma_f32 v[218:219], v[218:219], v[36:37], v[42:43] op_sel_hi:[1,0,1]
    ds_write_b128 v58, v[216:219] offset:0
    v_pk_fma_f32 v[44:45], v[240:241], v[38:39], v[244:245] op_sel:[0,1,0] op_sel_hi:[1,1,1]
    v_pk_fma_f32 v[220:221], v[220:221], v[38:39], v[44:45] op_sel_hi:[1,0,1]
    v_pk_fma_f32 v[46:47], v[242:243], v[38:39], v[246:247] op_sel:[0,1,0] op_sel_hi:[1,1,1]
    v_pk_fma_f32 v[222:223], v[222:223], v[38:39], v[46:47] op_sel_hi:[1,0,1]
    ds_write_b128 v58, v[220:223] offset:1024
    v_pk_fma_f32 v[40:41], v[224:225], v[32:33], v[228:229] op_sel:[0,1,0] op_sel_hi:[1,1,1]
    buffer_load_dwordx4 v[148:151], v249, s[84:87], s77 offen offset:0 sc1
    v_pk_fma_f32 v[176:177], v[176:177], v[32:33], v[40:41] op_sel_hi:[1,0,1]
    v_pk_fma_f32 v[42:43], v[226:227], v[32:33], v[230:231] op_sel:[0,1,0] op_sel_hi:[1,1,1]
    v_pk_fma_f32 v[178:179], v[178:179], v[32:33], v[42:43] op_sel_hi:[1,0,1]
    v_pk_fma_f32 v[44:45], v[224:225], v[34:35], v[228:229] op_sel:[0,1,0] op_sel_hi:[1,1,1]
    v_pk_fma_f32 v[180:181], v[180:181], v[34:35], v[44:45] op_sel_hi:[1,0,1]
    v_pk_fma_f32 v[46:47], v[226:227], v[34:35], v[230:231] op_sel:[0,1,0] op_sel_hi:[1,1,1]
    v_pk_fma_f32 v[182:183], v[182:183], v[34:35], v[46:47] op_sel_hi:[1,0,1]
    v_pk_fma_f32 v[40:41], v[232:233], v[32:33], v[236:237] op_sel:[0,1,0] op_sel_hi:[1,1,1]
    v_pk_fma_f32 v[192:193], v[192:193], v[32:33], v[40:41] op_sel_hi:[1,0,1]
    v_pk_fma_f32 v[42:43], v[234:235], v[32:33], v[238:239] op_sel:[0,1,0] op_sel_hi:[1,1,1]
    v_pk_fma_f32 v[194:195], v[194:195], v[32:33], v[42:43] op_sel_hi:[1,0,1]
    buffer_load_dwordx4 v[152:155], v249, s[84:87], s76 offen offset:1024 sc1
    v_pk_fma_f32 v[44:45], v[232:233], v[34:35], v[236:237] op_sel:[0,1,0] op_sel_hi:[1,1,1]
    v_pk_fma_f32 v[196:197], v[196:197], v[34:35], v[44:45] op_sel_hi:[1,0,1]
    v_pk_fma_f32 v[46:47], v[234:235], v[34:35], v[238:239] op_sel:[0,1,0] op_sel_hi:[1,1,1]
    v_pk_fma_f32 v[198:199], v[198:199], v[34:35], v[46:47] op_sel_hi:[1,0,1]
    v_pk_mul_f32 v[176:177], v[176:177], v[192:193]
    v_pk_mul_f32 v[178:179], v[178:179], v[194:195]
    v_cvt_pk_bf16_f32 v72, v176, v177
    v_cvt_pk_bf16_f32 v73, v178, v179
    v_pk_mul_f32 v[180:181], v[180:181], v[196:197]
    v_pk_mul_f32 v[182:183], v[182:183], v[198:199]
    buffer_load_dwordx4 v[156:159], v249, s[84:87], s77 offen offset:1024 sc1
    v_cvt_pk_bf16_f32 v74, v180, v181
    v_cvt_pk_bf16_f32 v75, v182, v183
    s_add_u32 s11, s30, s12
    s_add_u32 s11, s11, 176128
    v_permlane16_swap_b32 v72, v74
    v_permlane16_swap_b32 v73, v75
    buffer_store_dwordx4 v[72:75], v59, s[84:87], s11 offen sc1
    s_waitcnt lgkmcnt(0)
    s_barrier
    v_xor_b32 v63, 2048, v58
    ds_read_b128 v[216:219], v63 offset:0
    ds_read_b128 v[220:223], v63 offset:1024
    buffer_load_dwordx4 v[160:163], v249, s[84:87], s76 offen offset:2048 sc1
    v_pk_fma_f32 v[40:41], v[224:225], v[36:37], v[228:229] op_sel:[0,1,0] op_sel_hi:[1,1,1]
    v_pk_fma_f32 v[184:185], v[184:185], v[36:37], v[40:41] op_sel_hi:[1,0,1]
    v_pk_fma_f32 v[42:43], v[226:227], v[36:37], v[230:231] op_sel:[0,1,0] op_sel_hi:[1,1,1]
    v_pk_fma_f32 v[186:187], v[186:187], v[36:37], v[42:43] op_sel_hi:[1,0,1]
    v_pk_fma_f32 v[44:45], v[224:225], v[38:39], v[228:229] op_sel:[0,1,0] op_sel_hi:[1,1,1]
    v_pk_fma_f32 v[188:189], v[188:189], v[38:39], v[44:45] op_sel_hi:[1,0,1]
    v_pk_fma_f32 v[46:47], v[226:227], v[38:39], v[230:231] op_sel:[0,1,0] op_sel_hi:[1,1,1]
    v_pk_fma_f32 v[190:191], v[190:191], v[38:39], v[46:47] op_sel_hi:[1,0,1]
    v_pk_fma_f32 v[40:41], v[232:233], v[36:37], v[236:237] op_sel:[0,1,0] op_sel_hi:[1,1,1]
    v_pk_fma_f32 v[200:201], v[200:201], v[36:37], v[40:41] op_sel_hi:[1,0,1]
    buffer_load_dwordx4 v[164:167], v249, s[84:87], s77 offen offset:2048 sc1
    v_pk_fma_f32 v[42:43], v[234:235], v[36:37], v[238:239] op_sel:[0,1,0] op_sel_hi:[1,1,1]
    v_pk_fma_f32 v[202:203], v[202:203], v[36:37], v[42:43] op_sel_hi:[1,0,1]
    v_pk_fma_f32 v[44:45], v[232:233], v[38:39], v[236:237] op_sel:[0,1,0] op_sel_hi:[1,1,1]
    v_pk_fma_f32 v[204:205], v[204:205], v[38:39], v[44:45] op_sel_hi:[1,0,1]
    v_pk_fma_f32 v[46:47], v[234:235], v[38:39], v[238:239] op_sel:[0,1,0] op_sel_hi:[1,1,1]
    v_pk_fma_f32 v[206:207], v[206:207], v[38:39], v[46:47] op_sel_hi:[1,0,1]
    v_pk_mul_f32 v[184:185], v[184:185], v[200:201]
    v_pk_mul_f32 v[186:187], v[186:187], v[202:203]
    v_cvt_pk_bf16_f32 v76, v184, v185
    v_cvt_pk_bf16_f32 v77, v186, v187
    buffer_load_dwordx4 v[168:171], v249, s[84:87], s76 offen offset:3072 sc1
    v_pk_mul_f32 v[188:189], v[188:189], v[204:205]
    v_pk_mul_f32 v[190:191], v[190:191], v[206:207]
    v_cvt_pk_bf16_f32 v78, v188, v189
    v_cvt_pk_bf16_f32 v79, v190, v191
    s_add_u32 s11, s30, s13
    s_add_u32 s11, s11, 176128
    v_permlane16_swap_b32 v76, v78
    v_permlane16_swap_b32 v77, v79
    buffer_store_dwordx4 v[76:79], v59, s[84:87], s11 offen sc1
    v_pk_fma_f32 v[40:41], v[240:241], v[32:33], v[244:245] op_sel:[0,1,0] op_sel_hi:[1,1,1]
    v_pk_fma_f32 v[208:209], v[208:209], v[32:33], v[40:41] op_sel_hi:[1,0,1]
    buffer_load_dwordx4 v[172:175], v249, s[84:87], s77 offen offset:3072 sc1
    v_pk_fma_f32 v[42:43], v[242:243], v[32:33], v[246:247] op_sel:[0,1,0] op_sel_hi:[1,1,1]
    v_pk_fma_f32 v[210:211], v[210:211], v[32:33], v[42:43] op_sel_hi:[1,0,1]
    v_pk_fma_f32 v[44:45], v[240:241], v[34:35], v[244:245] op_sel:[0,1,0] op_sel_hi:[1,1,1]
    v_pk_fma_f32 v[212:213], v[212:213], v[34:35], v[44:45] op_sel_hi:[1,0,1]
    v_pk_fma_f32 v[46:47], v[242:243], v[34:35], v[246:247] op_sel:[0,1,0] op_sel_hi:[1,1,1]
    v_pk_fma_f32 v[214:215], v[214:215], v[34:35], v[46:47] op_sel_hi:[1,0,1]
    s_waitcnt lgkmcnt(0)
    v_pk_mul_f32 v[208:209], v[208:209], v[216:217]
    v_pk_mul_f32 v[210:211], v[210:211], v[218:219]
    v_cvt_pk_bf16_f32 v176, v208, v209
    v_cvt_pk_bf16_f32 v177, v210, v211
    v_pk_mul_f32 v[212:213], v[212:213], v[220:221]
    v_pk_mul_f32 v[214:215], v[214:215], v[222:223]
    v_cvt_pk_bf16_f32 v178, v212, v213
    v_cvt_pk_bf16_f32 v179, v214, v215
    s_add_u32 s11, s34, s12
    s_add_u32 s11, s11, 176128
    v_permlane16_swap_b32 v176, v178
    v_permlane16_swap_b32 v177, v179
    buffer_store_dwordx4 v[176:179], v59, s[84:87], s11 offen sc1
    v_add_u32 v60, 0x10000, v60
    buffer_load_dwordx4 v[96:99], v250, s[84:87], s76 offen offset:0 sc1
    s_waitcnt vmcnt(19)
    v_mfma_f32_16x16x32_bf16 v[176:179], a[192:195], v[112:115], 0
    ds_read_b64_tr_b16 a[0:1], v16 offset:32768
    v_mfma_f32_16x16x32_bf16 v[180:183], a[196:199], v[112:115], 0
    ds_read_b64_tr_b16 a[2:3], v16 offset:33280
    v_mfma_f32_16x16x32_bf16 v[184:187], a[200:203], v[112:115], 0
    ds_read_b64_tr_b16 a[4:5], v17 offset:32768
    v_mfma_f32_16x16x32_bf16 v[188:191], a[204:207], v[112:115], 0
    buffer_load_dwordx4 v[100:103], v250, s[84:87], s77 offen offset:0 sc1
    s_waitcnt vmcnt(19)
    v_mfma_f32_16x16x32_bf16 v[192:195], a[192:195], v[116:119], 0
    ds_read_b64_tr_b16 a[6:7], v17 offset:33280
    ds_read_b64_tr_b16 a[8:9], v18 offset:32768
    v_mfma_f32_16x16x32_bf16 v[196:199], a[196:199], v[116:119], 0
    ds_read_b64_tr_b16 a[10:11], v18 offset:33280
    v_mfma_f32_16x16x32_bf16 v[200:203], a[200:203], v[116:119], 0
    ds_read_b64_tr_b16 a[12:13], v19 offset:32768
    v_mfma_f32_16x16x32_bf16 v[204:207], a[204:207], v[116:119], 0
    buffer_load_dwordx4 v[104:107], v250, s[84:87], s76 offen offset:1024 sc1
    s_waitcnt vmcnt(19)
    v_mfma_f32_16x16x32_bf16 v[176:179], a[208:211], v[120:123], v[176:179]
    ds_read_b64_tr_b16 a[14:15], v19 offset:33280
    ds_read_b64_tr_b16 a[16:17], v16 offset:0
    v_mfma_f32_16x16x32_bf16 v[180:183], a[212:215], v[120:123], v[180:183]
    ds_read_b64_tr_b16 a[18:19], v16 offset:512
    v_mfma_f32_16x16x32_bf16 v[184:187], a[216:219], v[120:123], v[184:187]
    ds_read_b64_tr_b16 a[20:21], v17 offset:0
    v_mfma_f32_16x16x32_bf16 v[188:191], a[220:223], v[120:123], v[188:191]
    buffer_load_dwordx4 v[108:111], v250, s[84:87], s77 offen offset:1024 sc1
    s_waitcnt vmcnt(19)
    v_mfma_f32_16x16x32_bf16 v[192:195], a[208:211], v[124:127], v[192:195]
    ds_read_b64_tr_b16 a[22:23], v17 offset:512
    ds_read_b64_tr_b16 a[24:25], v18 offset:0
    v_mfma_f32_16x16x32_bf16 v[196:199], a[212:215], v[124:127], v[196:199]
    ds_read_b64_tr_b16 a[26:27], v18 offset:512
    v_mfma_f32_16x16x32_bf16 v[200:203], a[216:219], v[124:127], v[200:203]
    ds_read_b64_tr_b16 a[28:29], v19 offset:0
    v_mfma_f32_16x16x32_bf16 v[204:207], a[220:223], v[124:127], v[204:207]
    buffer_load_dwordx4 v[64:67], v251, s[84:87], s76 offen offset:2048 sc1
    s_waitcnt vmcnt(19)
    v_mfma_f32_16x16x32_bf16 v[176:179], a[224:227], v[128:131], v[176:179]
    ds_read_b64_tr_b16 a[30:31], v19 offset:512
    ds_read_b64_tr_b16 a[32:33], v16 offset:49152
    v_mfma_f32_16x16x32_bf16 v[180:183], a[228:231], v[128:131], v[180:183]
    ds_read_b64_tr_b16 a[34:35], v16 offset:49664
    v_mfma_f32_16x16x32_bf16 v[184:187], a[232:235], v[128:131], v[184:187]
    ds_read_b64_tr_b16 a[36:37], v17 offset:49152
    v_mfma_f32_16x16x32_bf16 v[188:191], a[236:239], v[128:131], v[188:191]
    buffer_load_dwordx4 v[68:71], v251, s[84:87], s77 offen offset:2048 sc1
    s_waitcnt vmcnt(19)
    v_mfma_f32_16x16x32_bf16 v[192:195], a[224:227], v[132:135], v[192:195]
    ds_read_b64_tr_b16 a[38:39], v17 offset:49664
    ds_read_b64_tr_b16 a[40:41], v18 offset:49152
    v_mfma_f32_16x16x32_bf16 v[196:199], a[228:231], v[132:135], v[196:199]
    ds_read_b64_tr_b16 a[42:43], v18 offset:49664
    v_mfma_f32_16x16x32_bf16 v[200:203], a[232:235], v[132:135], v[200:203]
    ds_read_b64_tr_b16 a[44:45], v19 offset:49152
    v_mfma_f32_16x16x32_bf16 v[204:207], a[236:239], v[132:135], v[204:207]
    ds_read_b64_tr_b16 a[46:47], v19 offset:49664
    s_waitcnt vmcnt(18)
    v_mfma_f32_16x16x32_bf16 v[176:179], a[240:243], v[136:139], v[176:179]
    ds_read_b64_tr_b16 a[48:49], v16 offset:16384
    v_mfma_f32_16x16x32_bf16 v[180:183], a[244:247], v[136:139], v[180:183]
    ds_read_b64_tr_b16 a[50:51], v16 offset:16896
    v_mfma_f32_16x16x32_bf16 v[184:187], a[248:251], v[136:139], v[184:187]
    ds_read_b64_tr_b16 a[52:53], v17 offset:16384
    v_mfma_f32_16x16x32_bf16 v[188:191], a[252:255], v[136:139], v[188:191]
    ds_read_b64_tr_b16 a[54:55], v17 offset:16896
    s_waitcnt vmcnt(17)
    v_mfma_f32_16x16x32_bf16 v[192:195], a[240:243], v[140:143], v[192:195]
    ds_read_b64_tr_b16 a[56:57], v18 offset:16384
    v_mfma_f32_16x16x32_bf16 v[196:199], a[244:247], v[140:143], v[196:199]
    ds_read_b64_tr_b16 a[58:59], v18 offset:16896
    v_mfma_f32_16x16x32_bf16 v[200:203], a[248:251], v[140:143], v[200:203]
    ds_read_b64_tr_b16 a[60:61], v19 offset:16384
    v_mfma_f32_16x16x32_bf16 v[204:207], a[252:255], v[140:143], v[204:207]
    ds_read_b64_tr_b16 a[62:63], v19 offset:16896
    s_lshl_b32 s11, s38, 4
    s_add_u32 s11, s11, s39
    s_lshl_b32 s11, s11, 7
    s_add_u32 s11, s11, 655360
    s_waitcnt vmcnt(6)
    s_barrier
    buffer_store_dword v4, v23, s[84:87], s11 offen sc1
    s_waitcnt lgkmcnt(15)
    v_mfma_f32_16x16x32_bf16 v[176:179], a[0:3], v[144:147], v[176:179]
    v_xor_b32 v16, 65536, v16
    v_xor_b32 v17, 65536, v17
    v_mfma_f32_16x16x32_bf16 v[180:183], a[4:7], v[144:147], v[180:183]
    v_xor_b32 v18, 65536, v18
    v_xor_b32 v19, 65536, v19
    v_mfma_f32_16x16x32_bf16 v[184:187], a[8:11], v[144:147], v[184:187]
    ds_read_b64_tr_b16 a[64:65], v16 offset:0
    ds_read_b64_tr_b16 a[66:67], v16 offset:512
    v_mfma_f32_16x16x32_bf16 v[188:191], a[12:15], v[144:147], v[188:191]
    ds_read_b64_tr_b16 a[68:69], v17 offset:0
    v_mfma_f32_16x16x32_bf16 v[192:195], a[0:3], v[148:151], v[192:195]
    ds_read_b64_tr_b16 a[70:71], v17 offset:512
    ds_read_b64_tr_b16 a[72:73], v18 offset:0
    v_mfma_f32_16x16x32_bf16 v[196:199], a[4:7], v[148:151], v[196:199]
    ds_read_b64_tr_b16 a[74:75], v18 offset:512
    ds_read_b64_tr_b16 a[76:77], v19 offset:0
    v_mfma_f32_16x16x32_bf16 v[200:203], a[8:11], v[148:151], v[200:203]
    ds_read_b64_tr_b16 a[78:79], v19 offset:512
    v_mfma_f32_16x16x32_bf16 v[204:207], a[12:15], v[148:151], v[204:207]
    s_waitcnt lgkmcnt(15)
    v_mfma_f32_16x16x32_bf16 v[176:179], a[16:19], v[152:155], v[176:179]
    ds_read_b64_tr_b16 a[80:81], v16 offset:16384
    ds_read_b64_tr_b16 a[82:83], v16 offset:16896
    v_mfma_f32_16x16x32_bf16 v[180:183], a[20:23], v[152:155], v[180:183]
    ds_read_b64_tr_b16 a[84:85], v17 offset:16384
    ds_read_b64_tr_b16 a[86:87], v17 offset:16896
    v_mfma_f32_16x16x32_bf16 v[184:187], a[24:27], v[152:155], v[184:187]
    ds_read_b64_tr_b16 a[88:89], v18 offset:16384
    ds_read_b64_tr_b16 a[90:91], v18 offset:16896
    v_mfma_f32_16x16x32_bf16 v[188:191], a[28:31], v[152:155], v[188:191]
    ds_read_b64_tr_b16 a[92:93], v19 offset:16384
    v_mfma_f32_16x16x32_bf16 v[192:195], a[16:19], v[156:159], v[192:195]
    ds_read_b64_tr_b16 a[94:95], v19 offset:16896
    ds_read_b64_tr_b16 a[96:97], v16 offset:32768
    v_mfma_f32_16x16x32_bf16 v[196:199], a[20:23], v[156:159], v[196:199]
    ds_read_b64_tr_b16 a[98:99], v16 offset:33280
    ds_read_b64_tr_b16 a[100:101], v17 offset:32768
    v_mfma_f32_16x16x32_bf16 v[200:203], a[24:27], v[156:159], v[200:203]
    ds_read_b64_tr_b16 a[102:103], v17 offset:33280
    ds_read_b64_tr_b16 a[104:105], v18 offset:32768
    v_mfma_f32_16x16x32_bf16 v[204:207], a[28:31], v[156:159], v[204:207]
    s_waitcnt lgkmcnt(15)
    v_mfma_f32_16x16x32_bf16 v[176:179], a[32:35], v[160:163], v[176:179]
    ds_read_b64_tr_b16 a[106:107], v18 offset:33280
    ds_read_b64_tr_b16 a[108:109], v19 offset:32768
    v_mfma_f32_16x16x32_bf16 v[180:183], a[36:39], v[160:163], v[180:183]
    ds_read_b64_tr_b16 a[110:111], v19 offset:33280
    v_mfma_f32_16x16x32_bf16 v[184:187], a[40:43], v[160:163], v[184:187]
    v_mfma_f32_16x16x32_bf16 v[188:191], a[44:47], v[160:163], v[188:191]
    v_mfma_f32_16x16x32_bf16 v[192:195], a[32:35], v[164:167], v[192:195]
    v_mfma_f32_16x16x32_bf16 v[196:199], a[36:39], v[164:167], v[196:199]
    v_mfma_f32_16x16x32_bf16 v[200:203], a[40:43], v[164:167], v[200:203]
    v_mfma_f32_16x16x32_bf16 v[204:207], a[44:47], v[164:167], v[204:207]
    s_waitcnt lgkmcnt(15)
    v_mfma_f32_16x16x32_bf16 v[176:179], a[48:51], v[168:171], v[176:179]
    v_mfma_f32_16x16x32_bf16 v[180:183], a[52:55], v[168:171], v[180:183]
    v_mfma_f32_16x16x32_bf16 v[184:187], a[56:59], v[168:171], v[184:187]
    v_mfma_f32_16x16x32_bf16 v[188:191], a[60:63], v[168:171], v[188:191]
    v_mfma_f32_16x16x32_bf16 v[192:195], a[48:51], v[172:175], v[192:195]
    v_mfma_f32_16x16x32_bf16 v[196:199], a[52:55], v[172:175], v[196:199]
    v_mfma_f32_16x16x32_bf16 v[200:203], a[56:59], v[172:175], v[200:203]
    v_mfma_f32_16x16x32_bf16 v[204:207], a[60:63], v[172:175], v[204:207]
    s_waitcnt lgkmcnt(15)
    s_waitcnt vmcnt(6)
    v_mfma_f32_16x16x32_bf16 v[176:179], a[64:67], v[96:99], v[176:179]
    v_mfma_f32_16x16x32_bf16 v[180:183], a[68:71], v[96:99], v[180:183]
    v_mfma_f32_16x16x32_bf16 v[184:187], a[72:75], v[96:99], v[184:187]
    v_mfma_f32_16x16x32_bf16 v[188:191], a[76:79], v[96:99], v[188:191]
    s_waitcnt vmcnt(5)
    v_mfma_f32_16x16x32_bf16 v[192:195], a[64:67], v[100:103], v[192:195]
    v_mfma_f32_16x16x32_bf16 v[196:199], a[68:71], v[100:103], v[196:199]
    v_mfma_f32_16x16x32_bf16 v[200:203], a[72:75], v[100:103], v[200:203]
    v_mfma_f32_16x16x32_bf16 v[204:207], a[76:79], v[100:103], v[204:207]
    s_waitcnt lgkmcnt(8)
    s_waitcnt vmcnt(4)
    v_mfma_f32_16x16x32_bf16 v[176:179], a[80:83], v[104:107], v[176:179]
    v_mfma_f32_16x16x32_bf16 v[180:183], a[84:87], v[104:107], v[180:183]
    v_mfma_f32_16x16x32_bf16 v[184:187], a[88:91], v[104:107], v[184:187]
    v_mfma_f32_16x16x32_bf16 v[188:191], a[92:95], v[104:107], v[188:191]
    s_waitcnt vmcnt(3)
    v_mfma_f32_16x16x32_bf16 v[192:195], a[80:83], v[108:111], v[192:195]
    v_mfma_f32_16x16x32_bf16 v[196:199], a[84:87], v[108:111], v[196:199]
    v_mfma_f32_16x16x32_bf16 v[200:203], a[88:91], v[108:111], v[200:203]
    v_mfma_f32_16x16x32_bf16 v[204:207], a[92:95], v[108:111], v[204:207]
    s_waitcnt lgkmcnt(0)
    s_waitcnt vmcnt(2)
    v_mfma_f32_16x16x32_bf16 v[176:179], a[96:99], v[64:67], v[176:179]
    v_mfma_f32_16x16x32_bf16 v[180:183], a[100:103], v[64:67], v[180:183]
    v_mfma_f32_16x16x32_bf16 v[184:187], a[104:107], v[64:67], v[184:187]
    v_mfma_f32_16x16x32_bf16 v[188:191], a[108:111], v[64:67], v[188:191]
    s_waitcnt vmcnt(1)
    v_mfma_f32_16x16x32_bf16 v[192:195], a[96:99], v[68:71], v[192:195]
    v_mfma_f32_16x16x32_bf16 v[196:199], a[100:103], v[68:71], v[196:199]
    v_mfma_f32_16x16x32_bf16 v[200:203], a[104:107], v[68:71], v[200:203]
    v_mfma_f32_16x16x32_bf16 v[204:207], a[108:111], v[68:71], v[204:207]
    buffer_load_dword v61, v60, s[84:87], 0 offen sc1
    s_waitcnt vmcnt(0)
    v_cmp_ne_u32 vcc, v61, v4
    s_cbranch_vccz Ldone_22
    s_mov_b32 s15, 0
    s_nop 3
Lspin_21:
    buffer_load_dword v61, v60, s[84:87], 0 offen sc1
    s_waitcnt vmcnt(0)
    v_cmp_ne_u32 vcc, v61, v4
    s_cbranch_vccz Ldone_22
    s_add_u32 s15, s15, 1
    s_cmp_lt_u32 s15, 400000
    s_cbranch_scc1 Lspin_21
Ldone_22:
    s_nop 1
    buffer_load_dwordx4 v[112:115], v248, s[84:87], s78 offen offset:0 sc1
    buffer_load_dwordx4 v[116:119], v248, s[84:87], s79 offen offset:0 sc1
    buffer_load_dwordx4 v[120:123], v248, s[84:87], s78 offen offset:1024 sc1
    buffer_load_dwordx4 v[124:127], v248, s[84:87], s79 offen offset:1024 sc1
    buffer_load_dwordx4 v[128:131], v248, s[84:87], s78 offen offset:2048 sc1
    buffer_load_dwordx4 v[132:135], v248, s[84:87], s79 offen offset:2048 sc1
    buffer_load_dwordx4 v[136:139], v248, s[84:87], s78 offen offset:3072 sc1
    buffer_load_dwordx4 v[140:143], v248, s[84:87], s79 offen offset:3072 sc1
    buffer_load_dwordx4 v[144:147], v249, s[84:87], s78 offen offset:0 sc1
    buffer_load_dwordx4 v[148:151], v249, s[84:87], s79 offen offset:0 sc1
    buffer_load_dwordx4 v[152:155], v249, s[84:87], s78 offen offset:1024 sc1
    buffer_load_dwordx4 v[156:159], v249, s[84:87], s79 offen offset:1024 sc1
    buffer_load_dwordx4 v[160:163], v249, s[84:87], s78 offen offset:2048 sc1
    buffer_load_dwordx4 v[164:167], v249, s[84:87], s79 offen offset:2048 sc1
    s_barrier
    s_xor_b32 s11, s5, 1
    s_mul_i32 s11, s11, 6144
    s_add_u32 s11, s11, 0
    v_add_u32 v6, s11, v5
    ds_write_b128 v6, v[192:195] offset:0
    ds_write_b128 v6, v[196:199] offset:1024
    s_xor_b32 s11, s5, 2
    s_mul_i32 s11, s11, 6144
    s_add_u32 s11, s11, 2048
    v_add_u32 v6, s11, v5
    ds_write_b128 v6, v[184:187] offset:0
    ds_write_b128 v6, v[188:191] offset:1024
    s_xor_b32 s11, s5, 3
    s_mul_i32 s11, s11, 6144
    s_add_u32 s11, s11, 4096
    v_add_u32 v6, s11, v5
    ds_write_b128 v6, v[200:203] offset:0
    ds_write_b128 v6, v[204:207] offset:1024
    ds_read_b128 v[240:243], v22 offset:10240
    ds_read_b128 v[244:247], v22 offset:10304
    v_lshlrev_b32 v21, 10, v20
    v_and_b32 v7, 1, v2
    v_lshl_add_u32 v21, v7, 5, v21
    v_lshrrev_b32 v7, 1, v2
    v_lshl_add_u32 v21, v7, 4, v21
    s_waitcnt lgkmcnt(0)
    s_barrier
    s_mul_i32 s11, s5, 6144
    s_add_u32 s11, s11, 0
    v_add_u32 v6, s11, v5
    ds_read_b128 v[192:195], v6 offset:0
    ds_read_b128 v[196:199], v6 offset:1024
    ds_read_b128 v[184:187], v6 offset:2048
    ds_read_b128 v[188:191], v6 offset:3072
    ds_read_b128 v[200:203], v6 offset:4096
    ds_read_b128 v[204:207], v6 offset:5120
    v_lshlrev_b32 v40, 16, v24
    v_and_b32 v41, s98, v24
    v_lshlrev_b32 v42, 16, v25
    v_and_b32 v43, s98, v25
    v_lshlrev_b32 v44, 16, v26
    v_and_b32 v45, s98, v26
    v_lshlrev_b32 v46, 16, v27
    v_and_b32 v47, s98, v27
    s_waitcnt lgkmcnt(0)
    v_pk_add_f32 v[32:33], v[176:177], v[192:193]
    v_pk_add_f32 v[184:185], v[184:185], v[200:201]
    v_pk_add_f32 v[34:35], v[178:179], v[194:195]
    v_pk_add_f32 v[186:187], v[186:187], v[202:203]
    v_pk_add_f32 v[36:37], v[180:181], v[196:197]
    v_pk_add_f32 v[188:189], v[188:189], v[204:205]
    v_pk_add_f32 v[38:39], v[182:183], v[198:199]
    v_pk_add_f32 v[190:191], v[190:191], v[206:207]
    v_pk_add_f32 v[32:33], v[32:33], v[184:185]
    v_pk_add_f32 v[34:35], v[34:35], v[186:187]
    v_pk_add_f32 v[36:37], v[36:37], v[188:189]
    v_pk_add_f32 v[38:39], v[38:39], v[190:191]
    v_pk_fma_f32 v[32:33], v[32:33], v[240:241], v[40:41]
    v_pk_fma_f32 v[34:35], v[34:35], v[242:243], v[42:43]
    v_pk_fma_f32 v[36:37], v[36:37], v[244:245], v[44:45]
    v_pk_fma_f32 v[38:39], v[38:39], v[246:247], v[46:47]
    v_cvt_pk_bf16_f32 v40, v32, v33
    v_cvt_pk_bf16_f32 v41, v34, v35
    v_cvt_pk_bf16_f32 v42, v36, v37
    v_cvt_pk_bf16_f32 v43, v38, v39
    s_lshl_b32 s12, s32, 6
    v_permlane16_swap_b32 v40, v42
    v_permlane16_swap_b32 v41, v43
    buffer_store_dwordx4 v[40:43], v21, s[80:83], s12 offen sc1
    buffer_load_dwordx4 v[168:171], v249, s[84:87], s78 offen offset:3072 sc1
    s_waitcnt vmcnt(15)
    v_mfma_f32_16x16x32_bf16 v[208:211], a[192:195], v[112:115], 0
    v_mfma_f32_16x16x32_bf16 v[212:215], a[196:199], v[112:115], 0
    v_mfma_f32_16x16x32_bf16 v[216:219], a[200:203], v[112:115], 0
    v_mfma_f32_16x16x32_bf16 v[220:223], a[204:207], v[112:115], 0
    buffer_load_dwordx4 v[172:175], v249, s[84:87], s79 offen offset:3072 sc1
    s_waitcnt vmcnt(15)
    v_mfma_f32_16x16x32_bf16 v[224:227], a[192:195], v[116:119], 0
    v_mfma_f32_16x16x32_bf16 v[228:231], a[196:199], v[116:119], 0
    v_mfma_f32_16x16x32_bf16 v[232:235], a[200:203], v[116:119], 0
    v_mfma_f32_16x16x32_bf16 v[236:239], a[204:207], v[116:119], 0
    buffer_load_dwordx4 v[96:99], v250, s[84:87], s78 offen offset:0 sc1
    s_waitcnt vmcnt(15)
    v_mfma_f32_16x16x32_bf16 v[208:211], a[208:211], v[120:123], v[208:211]
    v_mfma_f32_16x16x32_bf16 v[212:215], a[212:215], v[120:123], v[212:215]
    v_mfma_f32_16x16x32_bf16 v[216:219], a[216:219], v[120:123], v[216:219]
    v_mfma_f32_16x16x32_bf16 v[220:223], a[220:223], v[120:123], v[220:223]
    buffer_load_dwordx4 v[100:103], v250, s[84:87], s79 offen offset:0 sc1
    s_waitcnt vmcnt(15)
    v_mfma_f32_16x16x32_bf16 v[224:227], a[208:211], v[124:127], v[224:227]
    v_mfma_f32_16x16x32_bf16 v[228:231], a[212:215], v[124:127], v[228:231]
    v_mfma_f32_16x16x32_bf16 v[232:235], a[216:219], v[124:127], v[232:235]
    v_mfma_f32_16x16x32_bf16 v[236:239], a[220:223], v[124:127], v[236:239]
    buffer_load_dwordx4 v[104:107], v250, s[84:87], s78 offen offset:1024 sc1
    s_waitcnt vmcnt(15)
    v_mfma_f32_16x16x32_bf16 v[208:211], a[224:227], v[128:131], v[208:211]
    v_mfma_f32_16x16x32_bf16 v[212:215], a[228:231], v[128:131], v[212:215]
    v_mfma_f32_16x16x32_bf16 v[216:219], a[232:235], v[128:131], v[216:219]
    v_mfma_f32_16x16x32_bf16 v[220:223], a[236:239], v[128:131], v[220:223]
    buffer_load_dwordx4 v[108:111], v250, s[84:87], s79 offen offset:1024 sc1
    s_waitcnt vmcnt(15)
    v_mfma_f32_16x16x32_bf16 v[224:227], a[224:227], v[132:135], v[224:227]
    v_mfma_f32_16x16x32_bf16 v[228:231], a[228:231], v[132:135], v[228:231]
    v_mfma_f32_16x16x32_bf16 v[232:235], a[232:235], v[132:135], v[232:235]
    v_mfma_f32_16x16x32_bf16 v[236:239], a[236:239], v[132:135], v[236:239]
    buffer_load_dwordx4 v[64:67], v251, s[84:87], s78 offen offset:2048 sc1
    s_waitcnt vmcnt(15)
    v_mfma_f32_16x16x32_bf16 v[208:211], a[240:243], v[136:139], v[208:211]
    v_mfma_f32_16x16x32_bf16 v[212:215], a[244:247], v[136:139], v[212:215]
    v_mfma_f32_16x16x32_bf16 v[216:219], a[248:251], v[136:139], v[216:219]
    v_mfma_f32_16x16x32_bf16 v[220:223], a[252:255], v[136:139], v[220:223]
    buffer_load_dwordx4 v[68:71], v251, s[84:87], s79 offen offset:2048 sc1
    s_waitcnt vmcnt(15)
    v_mfma_f32_16x16x32_bf16 v[224:227], a[240:243], v[140:143], v[224:227]
    v_mfma_f32_16x16x32_bf16 v[228:231], a[244:247], v[140:143], v[228:231]
    v_mfma_f32_16x16x32_bf16 v[232:235], a[248:251], v[140:143], v[232:235]
    v_mfma_f32_16x16x32_bf16 v[236:239], a[252:255], v[140:143], v[236:239]
    s_waitcnt vmcnt(14)
    v_mfma_f32_16x16x32_bf16 v[208:211], a[0:3], v[144:147], v[208:211]
    v_mfma_f32_16x16x32_bf16 v[212:215], a[4:7], v[144:147], v[212:215]
    v_mfma_f32_16x16x32_bf16 v[216:219], a[8:11], v[144:147], v[216:219]
    v_mfma_f32_16x16x32_bf16 v[220:223], a[12:15], v[144:147], v[220:223]
    s_waitcnt vmcnt(13)
    v_mfma_f32_16x16x32_bf16 v[224:227], a[0:3], v[148:151], v[224:227]
    v_mfma_f32_16x16x32_bf16 v[228:231], a[4:7], v[148:151], v[228:231]
    v_mfma_f32_16x16x32_bf16 v[232:235], a[8:11], v[148:151], v[232:235]
    v_mfma_f32_16x16x32_bf16 v[236:239], a[12:15], v[148:151], v[236:239]
    s_waitcnt vmcnt(12)
    v_mfma_f32_16x16x32_bf16 v[208:211], a[16:19], v[152:155], v[208:211]
    v_mfma_f32_16x16x32_bf16 v[212:215], a[20:23], v[152:155], v[212:215]
    v_mfma_f32_16x16x32_bf16 v[216:219], a[24:27], v[152:155], v[216:219]
    v_mfma_f32_16x16x32_bf16 v[220:223], a[28:31], v[152:155], v[220:223]
    s_waitcnt vmcnt(11)
    v_mfma_f32_16x16x32_bf16 v[224:227], a[16:19], v[156:159], v[224:227]
    v_mfma_f32_16x16x32_bf16 v[228:231], a[20:23], v[156:159], v[228:231]
    v_mfma_f32_16x16x32_bf16 v[232:235], a[24:27], v[156:159], v[232:235]
    v_mfma_f32_16x16x32_bf16 v[236:239], a[28:31], v[156:159], v[236:239]
    s_waitcnt vmcnt(10)
    v_mfma_f32_16x16x32_bf16 v[208:211], a[32:35], v[160:163], v[208:211]
    v_mfma_f32_16x16x32_bf16 v[212:215], a[36:39], v[160:163], v[212:215]
    v_mfma_f32_16x16x32_bf16 v[216:219], a[40:43], v[160:163], v[216:219]
    v_mfma_f32_16x16x32_bf16 v[220:223], a[44:47], v[160:163], v[220:223]
    s_waitcnt vmcnt(9)
    v_mfma_f32_16x16x32_bf16 v[224:227], a[32:35], v[164:167], v[224:227]
    v_mfma_f32_16x16x32_bf16 v[228:231], a[36:39], v[164:167], v[228:231]
    v_mfma_f32_16x16x32_bf16 v[232:235], a[40:43], v[164:167], v[232:235]
    v_mfma_f32_16x16x32_bf16 v[236:239], a[44:47], v[164:167], v[236:239]
    s_waitcnt vmcnt(7)
    v_mfma_f32_16x16x32_bf16 v[208:211], a[48:51], v[168:171], v[208:211]
    v_mfma_f32_16x16x32_bf16 v[212:215], a[52:55], v[168:171], v[212:215]
    v_mfma_f32_16x16x32_bf16 v[216:219], a[56:59], v[168:171], v[216:219]
    v_mfma_f32_16x16x32_bf16 v[220:223], a[60:63], v[168:171], v[220:223]
    s_waitcnt vmcnt(6)
    v_mfma_f32_16x16x32_bf16 v[224:227], a[48:51], v[172:175], v[224:227]
    v_mfma_f32_16x16x32_bf16 v[228:231], a[52:55], v[172:175], v[228:231]
    v_mfma_f32_16x16x32_bf16 v[232:235], a[56:59], v[172:175], v[232:235]
    v_mfma_f32_16x16x32_bf16 v[236:239], a[60:63], v[172:175], v[236:239]
    s_waitcnt vmcnt(5)
    v_mfma_f32_16x16x32_bf16 v[208:211], a[64:67], v[96:99], v[208:211]
    v_mfma_f32_16x16x32_bf16 v[212:215], a[68:71], v[96:99], v[212:215]
    v_mfma_f32_16x16x32_bf16 v[216:219], a[72:75], v[96:99], v[216:219]
    v_mfma_f32_16x16x32_bf16 v[220:223], a[76:79], v[96:99], v[220:223]
    s_waitcnt vmcnt(4)
    v_mfma_f32_16x16x32_bf16 v[224:227], a[64:67], v[100:103], v[224:227]
    v_mfma_f32_16x16x32_bf16 v[228:231], a[68:71], v[100:103], v[228:231]
    v_mfma_f32_16x16x32_bf16 v[232:235], a[72:75], v[100:103], v[232:235]
    v_mfma_f32_16x16x32_bf16 v[236:239], a[76:79], v[100:103], v[236:239]
    s_waitcnt vmcnt(3)
    v_mfma_f32_16x16x32_bf16 v[208:211], a[80:83], v[104:107], v[208:211]
    v_mfma_f32_16x16x32_bf16 v[212:215], a[84:87], v[104:107], v[212:215]
    v_mfma_f32_16x16x32_bf16 v[216:219], a[88:91], v[104:107], v[216:219]
    v_mfma_f32_16x16x32_bf16 v[220:223], a[92:95], v[104:107], v[220:223]
    s_waitcnt vmcnt(2)
    v_mfma_f32_16x16x32_bf16 v[224:227], a[80:83], v[108:111], v[224:227]
    v_mfma_f32_16x16x32_bf16 v[228:231], a[84:87], v[108:111], v[228:231]
    v_mfma_f32_16x16x32_bf16 v[232:235], a[88:91], v[108:111], v[232:235]
    v_mfma_f32_16x16x32_bf16 v[236:239], a[92:95], v[108:111], v[236:239]
    s_waitcnt vmcnt(1)
    v_mfma_f32_16x16x32_bf16 v[208:211], a[96:99], v[64:67], v[208:211]
    v_mfma_f32_16x16x32_bf16 v[212:215], a[100:103], v[64:67], v[212:215]
    v_mfma_f32_16x16x32_bf16 v[216:219], a[104:107], v[64:67], v[216:219]
    v_mfma_f32_16x16x32_bf16 v[220:223], a[108:111], v[64:67], v[220:223]
    s_waitcnt vmcnt(0)
    v_mfma_f32_16x16x32_bf16 v[224:227], a[96:99], v[68:71], v[224:227]
    v_mfma_f32_16x16x32_bf16 v[228:231], a[100:103], v[68:71], v[228:231]
    v_mfma_f32_16x16x32_bf16 v[232:235], a[104:107], v[68:71], v[232:235]
    v_mfma_f32_16x16x32_bf16 v[236:239], a[108:111], v[68:71], v[236:239]
    s_xor_b32 s11, s5, 1
    s_mul_i32 s11, s11, 6144
    s_add_u32 s11, s11, 24576
    v_add_u32 v6, s11, v5
    s_nop 0
    ds_write_b128 v6, v[224:227] offset:0
    ds_write_b128 v6, v[228:231] offset:1024
    s_xor_b32 s11, s5, 2
    s_mul_i32 s11, s11, 6144
    s_add_u32 s11, s11, 26624
    v_add_u32 v6, s11, v5
    ds_write_b128 v6, v[216:219] offset:0
    ds_write_b128 v6, v[220:223] offset:1024
    s_xor_b32 s11, s5, 3
    s_mul_i32 s11, s11, 6144
    s_add_u32 s11, s11, 28672
    v_add_u32 v6, s11, v5
    ds_write_b128 v6, v[232:235] offset:0
    ds_write_b128 v6, v[236:239] offset:1024
    s_waitcnt lgkmcnt(0)
    s_barrier
    s_mul_i32 s11, s5, 6144
    s_add_u32 s11, s11, 24576
    v_add_u32 v6, s11, v5
    ds_read_b128 v[224:227], v6 offset:0
    ds_read_b128 v[228:231], v6 offset:1024
    ds_read_b128 v[216:219], v6 offset:2048
    ds_read_b128 v[220:223], v6 offset:3072
    ds_read_b128 v[232:235], v6 offset:4096
    ds_read_b128 v[236:239], v6 offset:5120
    v_lshlrev_b32 v56, 16, v28
    v_and_b32 v57, s98, v28
    v_lshlrev_b32 v58, 16, v29
    v_and_b32 v59, s98, v29
    v_lshlrev_b32 v60, 16, v30
    v_and_b32 v61, s98, v30
    v_lshlrev_b32 v62, 16, v31
    v_and_b32 v63, s98, v31
    s_waitcnt lgkmcnt(0)
    v_pk_add_f32 v[48:49], v[208:209], v[224:225]
    v_pk_add_f32 v[216:217], v[216:217], v[232:233]
    v_pk_add_f32 v[50:51], v[210:211], v[226:227]
    v_pk_add_f32 v[218:219], v[218:219], v[234:235]
    v_pk_add_f32 v[52:53], v[212:213], v[228:229]
    v_pk_add_f32 v[220:221], v[220:221], v[236:237]
    v_pk_add_f32 v[54:55], v[214:215], v[230:231]
    v_pk_add_f32 v[222:223], v[222:223], v[238:239]
    v_pk_add_f32 v[48:49], v[48:49], v[216:217]
    v_pk_add_f32 v[50:51], v[50:51], v[218:219]
    v_pk_add_f32 v[52:53], v[52:53], v[220:221]
    v_pk_add_f32 v[54:55], v[54:55], v[222:223]
    v_pk_fma_f32 v[48:49], v[48:49], v[240:241], v[56:57]
    v_pk_fma_f32 v[50:51], v[50:51], v[242:243], v[58:59]
    v_pk_fma_f32 v[52:53], v[52:53], v[244:245], v[60:61]
    v_pk_fma_f32 v[54:55], v[54:55], v[246:247], v[62:63]
    v_cvt_pk_bf16_f32 v56, v48, v49
    v_cvt_pk_bf16_f32 v57, v50, v51
    v_cvt_pk_bf16_f32 v58, v52, v53
    v_cvt_pk_bf16_f32 v59, v54, v55
    s_lshl_b32 s12, s32, 6
    s_add_u32 s12, s12, 65536
    v_permlane16_swap_b32 v56, v58
    v_permlane16_swap_b32 v57, v59
    buffer_store_dwordx4 v[56:59], v21, s[80:83], s12 offen sc1
    s_lshl_b32 s11, s2, 8
    v_or_b32 v6, s11, v0
    v_cmp_eq_u32 vcc, 0, v6
    v_mov_b32 v7, 2147483632
    s_nop 0
    v_cndmask_b32 v7, v7, 0, vcc
    buffer_store_dword v4, v7, s[84:87], 0 offen
L_end:
    s_endpgm
L_code_end:
.section .rodata,"a"
.p2align 6
.amdhsa_kernel adaLN_cond__linear_kernel_hedgehog__glu_gated_bilinear__prompt_kernel
  .amdhsa_next_free_vgpr 512
  .amdhsa_next_free_sgpr 102
  .amdhsa_accum_offset 256
  .amdhsa_group_segment_fixed_size 0
  .amdhsa_kernarg_size 104
  .amdhsa_user_sgpr_count 2
  .amdhsa_user_sgpr_kernarg_segment_ptr 1
  .amdhsa_system_sgpr_workgroup_id_x 1
.end_amdhsa_kernel
```
